```python
import torch

def _softmax(x, axis=-1):
    return torch.softmax(x, dim=axis)
def _gelu(x):
    return torch.nn.functional.gelu(x, approximate="tanh")
def _silu(x):
    return torch.nn.functional.silu(x)
def _sigmoid(x):
    return torch.sigmoid(x)
def _layernorm(x, axis=-1, eps=1e-5):
    m = x.mean(dim=axis, keepdim=True)
    v = x.var(dim=axis, keepdim=True, unbiased=False)
    return (x - m) / torch.sqrt(v + eps)
def _scatter_add(tgt, idx, src, axis=0):
    return tgt.clone().index_add_(axis, idx, src)
def _segment_sum(src, seg, n):
    out = torch.zeros((n,) + src.shape[1:], dtype=src.dtype)
    return out.index_add_(0, seg, src)
def _pad(x, pw):
    flat = tuple(v for pair in reversed(pw) for v in pair)
    return torch.nn.functional.pad(x, flat)

kernel_name = 'standalone__linear_kernel_rfa__decode'

def setup_inputs():

    _w = (lambda a: (lambda t: t.to(torch.bfloat16) if t.is_floating_point() else t)(torch.as_tensor(a)))
    B, H, Sq, Sk, D, M = 4, 32, 1, 8192, 128, 64
    return {
        "q": _w((lambda *s: torch.randn(*s, dtype=torch.bfloat16) * 0.4)(B, H, Sq, D)),
        "k": _w((lambda *s: torch.randn(*s, dtype=torch.bfloat16) * 1.6)(B, H, Sk, D)),
        "v": _w((lambda *s: torch.randn(*s, dtype=torch.bfloat16) * 1.6)(B, H, Sk, D)),
        "omega": _w((lambda *s: torch.randn(*s, dtype=torch.bfloat16) * 1.6)(M, D)),
    }

def reference(q, k, v, omega):
    d = q.shape[-1]
    m = omega.shape[0]
    scale = float(d) ** -0.25
    qs = q * scale
    ks = k * scale
    q_proj = torch.einsum("bhsd,md->bhsm", qs, omega)
    k_proj = torch.einsum("bhsd,md->bhsm", ks, omega)
    q_sq = 0.5 * torch.einsum("bhsd,bhsd->bhs", qs, qs)[..., None]
    k_sq = 0.5 * torch.einsum("bhsd,bhsd->bhs", ks, ks)[..., None]
    inv_sqrt_m = float(m) ** -0.5
    phi_q = torch.exp(q_proj - q_sq) * inv_sqrt_m + 1e-6
    phi_k = torch.exp(k_proj - k_sq) * inv_sqrt_m + 1e-6
    kv = torch.einsum("bhsm,bhsd->bhmd", phi_k, v)
    z  = torch.einsum("bhsm->bhm", phi_k)
    num = torch.einsum("bhqm,bhmd->bhqd", phi_q, kv)
    den = torch.einsum("bhqm,bhm->bhq", phi_q, z)[..., None] + 1e-6
    return num / den
```

```asm
; @launch grid=(256,1,1) block=(256,1,1) lds=82944
.amdgcn_target "amdgcn-amd-amdhsa--gfx950"
.text
.globl standalone__linear_kernel_rfa__decode_kernel
.p2align 8
.type standalone__linear_kernel_rfa__decode_kernel,@function
standalone__linear_kernel_rfa__decode_kernel:
    s_cmp_ge_u32 s2, 256
    s_cbranch_scc1 L_end
    s_load_dwordx8 s[4:11], s[0:1], 0
    s_load_dwordx4 s[12:15], s[0:1], 32
    s_load_dwordx2 s[16:17], s[0:1], 48
    v_lshrrev_b32 v7, 6, v0
    v_and_b32 v0, 63, v0
    v_readfirstlane_b32 s42, v7
    v_and_b32 v6, 15, v0
    v_lshrrev_b32 v7, 4, v0
    v_lshlrev_b32 v2, 4, v0
    v_lshlrev_b32 v1, 2, v7
    v_xor_b32 v1, v1, v6
    v_xor_b32 v164, 0, v1
    v_lshlrev_b32 v164, 4, v164
    v_lshl_add_u32 v164, v7, 8, v164
    v_xor_b32 v165, 1, v1
    v_lshlrev_b32 v165, 4, v165
    v_lshl_add_u32 v165, v7, 8, v165
    v_xor_b32 v166, 2, v1
    v_lshlrev_b32 v166, 4, v166
    v_lshl_add_u32 v166, v7, 8, v166
    v_xor_b32 v167, 3, v1
    v_lshlrev_b32 v167, 4, v167
    v_lshl_add_u32 v167, v7, 8, v167
    s_lshr_b32 s41, s2, 1
    s_mul_i32 s54, s42, 16384
    s_add_u32 s54, s54, 17408
    s_lshl_b32 s43, s41, 21
    s_lshl_b32 s45, s42, 12
    s_movk_i32 s37, 16384
    s_and_b32 s44, s2, 1
    s_cselect_b32 s44, 2031616, 0
    s_cselect_b32 s37, 4294852608, s37
    s_add_u32 s45, s45, s44
    s_mov_b32 s36, s45
    s_mov_b32 s22, 2097152
    s_mov_b32 s23, 0x00020000
    s_mov_b32 s26, 2097152
    s_mov_b32 s27, 0x00020000
    s_mov_b32 s30, 16384
    s_mov_b32 s31, 0x00020000
    s_mov_b32 s34, 32768
    s_mov_b32 s35, 0x00020000
    s_lshl_b32 s44, s42, 12
    s_mov_b32 m0, s44
    v_lshlrev_b32 v1, 4, v7
    s_waitcnt lgkmcnt(0)
    s_mov_b32 s28, s10
    s_and_b32 s29, s11, 0xffff
    buffer_load_dwordx4 v164, s[28:31], s44 offen offset:0 lds
    buffer_load_dwordx4 v165, s[28:31], s44 offen offset:1024 lds
    buffer_load_dwordx4 v166, s[28:31], s44 offen offset:2048 lds
    buffer_load_dwordx4 v167, s[28:31], s44 offen offset:3072 lds
    s_mov_b32 s32, s4
    s_and_b32 s33, s5, 0xffff
    s_lshl_b32 s44, s41, 8
    s_add_u32 s20, s6, s43
    s_addc_u32 s21, s7, 0
    s_and_b32 s21, s21, 0xffff
    buffer_load_dwordx4 v[32:35], v1, s[32:35], s44 offen offset:0
    buffer_load_dwordx4 v[36:39], v1, s[32:35], s44 offen offset:64
    buffer_load_dwordx4 v[40:43], v1, s[32:35], s44 offen offset:128
    buffer_load_dwordx4 v[44:47], v1, s[32:35], s44 offen offset:192
    s_add_u32 m0, s54, 0
    s_nop 0
    buffer_load_dwordx4 v164, s[20:23], s36 offen offset:0 nt lds
    buffer_load_dwordx4 v165, s[20:23], s36 offen offset:1024 nt lds
    buffer_load_dwordx4 v166, s[20:23], s36 offen offset:2048 nt lds
    buffer_load_dwordx4 v167, s[20:23], s36 offen offset:3072 nt lds
    s_add_u32 s36, s36, 16384
    s_add_u32 m0, s54, 4096
    s_nop 0
    buffer_load_dwordx4 v164, s[20:23], s36 offen offset:0 nt lds
    buffer_load_dwordx4 v165, s[20:23], s36 offen offset:1024 nt lds
    buffer_load_dwordx4 v166, s[20:23], s36 offen offset:2048 nt lds
    buffer_load_dwordx4 v167, s[20:23], s36 offen offset:3072 nt lds
    s_add_u32 s36, s36, 16384
    s_add_u32 m0, s54, 8192
    s_nop 0
    buffer_load_dwordx4 v164, s[20:23], s36 offen offset:0 nt lds
    buffer_load_dwordx4 v165, s[20:23], s36 offen offset:1024 nt lds
    buffer_load_dwordx4 v166, s[20:23], s36 offen offset:2048 nt lds
    buffer_load_dwordx4 v167, s[20:23], s36 offen offset:3072 nt lds
    s_add_u32 s36, s36, 16384
    s_add_u32 m0, s54, 12288
    s_nop 0
    buffer_load_dwordx4 v164, s[20:23], s36 offen offset:0 nt lds
    buffer_load_dwordx4 v165, s[20:23], s36 offen offset:1024 nt lds
    buffer_load_dwordx4 v166, s[20:23], s36 offen offset:2048 nt lds
    buffer_load_dwordx4 v167, s[20:23], s36 offen offset:3072 nt lds
    s_add_u32 s36, s36, s37
    s_add_u32 s24, s8, s43
    s_addc_u32 s25, s9, 0
    s_and_b32 s25, s25, 0xffff
    s_mov_b32 s38, 0x3edb9ada
    s_mov_b32 s39, 0x3e000000
    v_mov_b32 v3, 0xbd8293ee
    v_mov_b32 v4, 1.0
    v_lshlrev_b32 v1, 2, v7
    v_sub_u32 v1, v6, v1
    v_cmp_eq_u32 s[46:47], 0, v1
    v_cmp_eq_u32 s[48:49], 1, v1
    v_cmp_eq_u32 s[50:51], 2, v1
    v_cmp_eq_u32 s[52:53], 3, v1
    v_and_b32 v1, 1, v6
    v_lshlrev_b32 v1, 4, v1
    v_mov_b32 v8, 0xffff
    v_lshlrev_b32 v8, v1, v8
    v_bfe_u32 v1, v6, 1, 2
    v_cmp_eq_u32 vcc, 0, v1
    s_nop 1
    v_cndmask_b32 v16, 0, v8, vcc
    v_cmp_eq_u32 vcc, 1, v1
    s_nop 1
    v_cndmask_b32 v17, 0, v8, vcc
    v_cmp_eq_u32 vcc, 2, v1
    s_nop 1
    v_cndmask_b32 v18, 0, v8, vcc
    v_cmp_eq_u32 vcc, 3, v1
    s_nop 1
    v_cndmask_b32 v19, 0, v8, vcc
    v_and_b32 v1, 3, v6
    v_lshlrev_b32 v1, 10, v1
    v_lshrrev_b32 v8, 2, v6
    v_lshl_add_u32 v1, v8, 8, v1
    v_xor_b32 v8, v7, v6
    v_xor_b32 v168, 0, v8
    v_lshl_add_u32 v168, v168, 4, v1
    v_xor_b32 v169, 4, v8
    v_lshl_add_u32 v169, v169, 4, v1
    v_xor_b32 v170, 8, v8
    v_lshl_add_u32 v170, v170, 4, v1
    v_xor_b32 v171, 12, v8
    v_lshl_add_u32 v171, v171, 4, v1
    s_mul_i32 s44, s42, 4160
    s_add_u32 s44, s44, 320
    v_lshlrev_b32 v128, 4, v7
    v_add_u32 v128, s44, v128
    v_lshlrev_b32 v129, 5, v6
    v_lshl_add_u32 v129, v7, 4, v129
    v_cmp_lt_u32 vcc, 31, v0
    v_mov_b32 v7, 0x358637bd
    s_mov_b32 s40, 14
    v_cndmask_b32 v129, v129, v2, vcc
    v_add_u32 v129, s54, v129
    s_waitcnt vmcnt(16)
    s_barrier
    ds_read_b128 v[64:67], v168 offset:0
    ds_read_b128 v[68:71], v169 offset:0
    ds_read_b128 v[72:75], v170 offset:0
    ds_read_b128 v[76:79], v171 offset:0
    ds_read_b128 v[80:83], v168 offset:4096
    ds_read_b128 v[84:87], v169 offset:4096
    ds_read_b128 v[88:91], v170 offset:4096
    ds_read_b128 v[92:95], v171 offset:4096
    ds_read_b128 v[96:99], v168 offset:8192
    ds_read_b128 v[100:103], v169 offset:8192
    ds_read_b128 v[104:107], v170 offset:8192
    ds_read_b128 v[108:111], v171 offset:8192
    ds_read_b128 v[112:115], v168 offset:12288
    ds_read_b128 v[116:119], v169 offset:12288
    ds_read_b128 v[120:123], v170 offset:12288
    ds_read_b128 v[124:127], v171 offset:12288
    v_add_u32 v168, s54, v168
    v_add_u32 v169, s54, v169
    v_add_u32 v170, s54, v170
    v_add_u32 v171, s54, v171
    v_mfma_f32_16x16x32_bf16 v[8:11], v[32:35], v[32:35], 0
    v_mfma_f32_16x16x32_bf16 v[8:11], v[36:39], v[36:39], v[8:11]
    v_mfma_f32_16x16x32_bf16 v[8:11], v[40:43], v[40:43], v[8:11]
    v_mfma_f32_16x16x32_bf16 v[8:11], v[44:47], v[44:47], v[8:11]
    s_waitcnt lgkmcnt(0)
    s_barrier
    v_mfma_f32_16x16x32_bf16 v[48:51], v[64:67], v[32:35], 0
    v_mfma_f32_16x16x32_bf16 v[48:51], v[68:71], v[36:39], v[48:51]
    v_mfma_f32_16x16x32_bf16 v[48:51], v[72:75], v[40:43], v[48:51]
    v_mfma_f32_16x16x32_bf16 v[48:51], v[76:79], v[44:47], v[48:51]
    v_mfma_f32_16x16x32_bf16 v[52:55], v[80:83], v[32:35], 0
    v_mfma_f32_16x16x32_bf16 v[52:55], v[84:87], v[36:39], v[52:55]
    v_mfma_f32_16x16x32_bf16 v[52:55], v[88:91], v[40:43], v[52:55]
    v_mfma_f32_16x16x32_bf16 v[52:55], v[92:95], v[44:47], v[52:55]
    v_mfma_f32_16x16x32_bf16 v[56:59], v[96:99], v[32:35], 0
    v_mfma_f32_16x16x32_bf16 v[56:59], v[100:103], v[36:39], v[56:59]
    v_mfma_f32_16x16x32_bf16 v[56:59], v[104:107], v[40:43], v[56:59]
    v_mfma_f32_16x16x32_bf16 v[56:59], v[108:111], v[44:47], v[56:59]
    v_mfma_f32_16x16x32_bf16 v[60:63], v[112:115], v[32:35], 0
    v_mfma_f32_16x16x32_bf16 v[60:63], v[116:119], v[36:39], v[60:63]
    v_mfma_f32_16x16x32_bf16 v[60:63], v[120:123], v[40:43], v[60:63]
    v_mfma_f32_16x16x32_bf16 v[60:63], v[124:127], v[44:47], v[60:63]
    v_mul_f32 v8, v3, v8
    s_nop 7
    v_fma_f32 v48, v48, s38, v8
    v_fma_f32 v49, v49, s38, v8
    v_fma_f32 v50, v50, s38, v8
    v_fma_f32 v51, v51, s38, v8
    v_fma_f32 v52, v52, s38, v8
    v_fma_f32 v53, v53, s38, v8
    v_fma_f32 v54, v54, s38, v8
    v_fma_f32 v55, v55, s38, v8
    v_fma_f32 v56, v56, s38, v8
    v_fma_f32 v57, v57, s38, v8
    v_fma_f32 v58, v58, s38, v8
    v_fma_f32 v59, v59, s38, v8
    v_fma_f32 v60, v60, s38, v8
    v_fma_f32 v61, v61, s38, v8
    v_fma_f32 v62, v62, s38, v8
    v_fma_f32 v63, v63, s38, v8
    v_exp_f32 v48, v48
    v_exp_f32 v49, v49
    v_exp_f32 v50, v50
    v_exp_f32 v51, v51
    v_exp_f32 v52, v52
    v_exp_f32 v53, v53
    v_exp_f32 v54, v54
    v_exp_f32 v55, v55
    v_exp_f32 v56, v56
    v_exp_f32 v57, v57
    v_exp_f32 v58, v58
    v_exp_f32 v59, v59
    v_exp_f32 v60, v60
    v_exp_f32 v61, v61
    v_exp_f32 v62, v62
    v_exp_f32 v63, v63
    s_waitcnt vmcnt(12)
    ds_read_b128 v[132:135], v168 offset:0
    ds_read_b128 v[136:139], v169 offset:0
    ds_read_b128 v[140:143], v170 offset:0
    ds_read_b128 v[144:147], v171 offset:0
    v_fma_f32 v48, v48, s39, v7
    v_fma_f32 v49, v49, s39, v7
    v_fma_f32 v50, v50, s39, v7
    v_fma_f32 v51, v51, s39, v7
    v_fma_f32 v52, v52, s39, v7
    v_fma_f32 v53, v53, s39, v7
    v_fma_f32 v54, v54, s39, v7
    v_fma_f32 v55, v55, s39, v7
    v_fma_f32 v56, v56, s39, v7
    v_fma_f32 v57, v57, s39, v7
    v_fma_f32 v58, v58, s39, v7
    v_fma_f32 v59, v59, s39, v7
    v_fma_f32 v60, v60, s39, v7
    v_fma_f32 v61, v61, s39, v7
    v_fma_f32 v62, v62, s39, v7
    v_fma_f32 v63, v63, s39, v7
    v_add_f32 v6, v48, v49
    v_add_f32 v6, v6, v50
    v_add_f32 v6, v6, v51
    v_add_f32 v6, v6, v52
    v_add_f32 v6, v6, v53
    v_add_f32 v6, v6, v54
    v_add_f32 v6, v6, v55
    v_add_f32 v6, v6, v56
    v_add_f32 v6, v6, v57
    v_add_f32 v6, v6, v58
    v_add_f32 v6, v6, v59
    v_add_f32 v6, v6, v60
    v_add_f32 v6, v6, v61
    v_add_f32 v6, v6, v62
    v_add_f32 v6, v6, v63
    v_mul_f32 v32, s39, v48
    v_mul_f32 v33, s39, v49
    v_mul_f32 v34, s39, v50
    v_mul_f32 v35, s39, v51
    v_mul_f32 v36, s39, v52
    v_mul_f32 v37, s39, v53
    v_mul_f32 v38, s39, v54
    v_mul_f32 v39, s39, v55
    v_mul_f32 v40, s39, v56
    v_mul_f32 v41, s39, v57
    v_mul_f32 v42, s39, v58
    v_mul_f32 v43, s39, v59
    v_mul_f32 v44, s39, v60
    v_mul_f32 v45, s39, v61
    v_mul_f32 v46, s39, v62
    v_mul_f32 v47, s39, v63
    v_mfma_f32_16x16x4_f32 v[12:15], v7, v6, 0
    s_getreg_b32 s43, hwreg(HW_REG_XCC_ID, 0, 1)
    s_cmp_eq_u32 s43, 0
    s_cselect_b64 vcc, -1, 0
    s_waitcnt lgkmcnt(0)
    s_add_u32 m0, s54, 0
    s_waitcnt vmcnt(9)
    buffer_load_dwordx4 v164, s[20:23], s36 offen offset:0 nt lds
    v_mfma_f32_16x16x32_bf16 v[8:11], v[132:135], v[132:135], 0
    v_mfma_f32_16x16x32_bf16 v[8:11], v[136:139], v[136:139], v[8:11]
    v_mfma_f32_16x16x32_bf16 v[8:11], v[140:143], v[140:143], v[8:11]
    v_mfma_f32_16x16x32_bf16 v[8:11], v[144:147], v[144:147], v[8:11]
    v_mfma_f32_16x16x32_bf16 v[48:51], v[64:67], v[132:135], 0
    v_mfma_f32_16x16x32_bf16 v[48:51], v[68:71], v[136:139], v[48:51]
    v_mfma_f32_16x16x32_bf16 v[48:51], v[72:75], v[140:143], v[48:51]
    v_mfma_f32_16x16x32_bf16 v[48:51], v[76:79], v[144:147], v[48:51]
    v_mfma_f32_16x16x32_bf16 v[52:55], v[80:83], v[132:135], 0
    v_mfma_f32_16x16x32_bf16 v[52:55], v[84:87], v[136:139], v[52:55]
    v_mfma_f32_16x16x32_bf16 v[52:55], v[88:91], v[140:143], v[52:55]
    v_mfma_f32_16x16x32_bf16 v[52:55], v[92:95], v[144:147], v[52:55]
    s_waitcnt vmcnt(9)
    buffer_load_dwordx4 v165, s[20:23], s36 offen offset:1024 nt lds
    v_cndmask_b32 v7, 0, v8, s[46:47]
    v_cndmask_b32 v7, v7, v9, s[48:49]
    v_cndmask_b32 v7, v7, v10, s[50:51]
    v_cndmask_b32 v7, v7, v11, s[52:53]
    v_mfma_f32_16x16x32_bf16 v[56:59], v[96:99], v[132:135], 0
    v_mfma_f32_16x16x32_bf16 v[56:59], v[100:103], v[136:139], v[56:59]
    v_mfma_f32_16x16x4_f32 v[8:11], v3, v7, 0
    v_mfma_f32_16x16x32_bf16 v[56:59], v[104:107], v[140:143], v[56:59]
    v_mfma_f32_16x16x32_bf16 v[56:59], v[108:111], v[144:147], v[56:59]
    v_cvt_pk_bf16_f32 v24, v24, v24
    v_cvt_pk_bf16_f32 v25, v25, v25
    v_cvt_pk_bf16_f32 v26, v26, v26
    v_cvt_pk_bf16_f32 v27, v27, v27
    ds_write_b128 v128, v[24:27] offset:192
    v_add_u32 v128, 256, v128
    v_mfma_f32_16x16x32_bf16 v[60:63], v[112:115], v[132:135], 0
    v_mfma_f32_16x16x32_bf16 v[60:63], v[116:119], v[136:139], v[60:63]
    v_mfma_f32_16x16x32_bf16 v[60:63], v[120:123], v[140:143], v[60:63]
    v_mfma_f32_16x16x32_bf16 v[60:63], v[124:127], v[144:147], v[60:63]
    s_waitcnt vmcnt(9)
    buffer_load_dwordx4 v166, s[20:23], s36 offen offset:2048 nt lds
    s_waitcnt vmcnt(11)
    ds_read_b128 v[148:151], v168 offset:4096
    ds_read_b128 v[152:155], v169 offset:4096
    ds_read_b128 v[156:159], v170 offset:4096
    ds_read_b128 v[160:163], v171 offset:4096
    v_fma_f32 v48, v48, s38, v8
    v_fma_f32 v49, v49, s38, v8
    v_exp_f32 v48, v48
    v_exp_f32 v49, v49
    v_mul_f32 v6, v48, v32
    v_fmac_f32 v6, v49, v33
    v_fma_f32 v50, v50, s38, v8
    v_fma_f32 v51, v51, s38, v8
    v_exp_f32 v50, v50
    v_exp_f32 v51, v51
    v_fmac_f32 v6, v50, v34
    v_fmac_f32 v6, v51, v35
    v_fma_f32 v52, v52, s38, v8
    v_fma_f32 v53, v53, s38, v8
    v_exp_f32 v52, v52
    v_exp_f32 v53, v53
    v_fmac_f32 v6, v52, v36
    v_fmac_f32 v6, v53, v37
    v_fma_f32 v54, v54, s38, v8
    v_fma_f32 v55, v55, s38, v8
    v_exp_f32 v54, v54
    v_exp_f32 v55, v55
    v_fmac_f32 v6, v54, v38
    v_fmac_f32 v6, v55, v39
    s_waitcnt vmcnt(9)
    buffer_load_dwordx4 v167, s[20:23], s36 offen offset:3072 nt lds
    s_add_u32 s36, s36, 16384
    v_fma_f32 v56, v56, s38, v8
    v_fma_f32 v57, v57, s38, v8
    v_exp_f32 v56, v56
    v_exp_f32 v57, v57
    v_fmac_f32 v6, v56, v40
    v_fmac_f32 v6, v57, v41
    v_fma_f32 v58, v58, s38, v8
    v_fma_f32 v59, v59, s38, v8
    v_exp_f32 v58, v58
    v_exp_f32 v59, v59
    v_fmac_f32 v6, v58, v42
    v_fmac_f32 v6, v59, v43
    v_fma_f32 v60, v60, s38, v8
    v_fma_f32 v61, v61, s38, v8
    v_exp_f32 v60, v60
    v_exp_f32 v61, v61
    v_fmac_f32 v6, v60, v44
    v_fmac_f32 v6, v61, v45
    v_fma_f32 v62, v62, s38, v8
    v_fma_f32 v63, v63, s38, v8
    v_exp_f32 v62, v62
    v_exp_f32 v63, v63
    v_fmac_f32 v6, v62, v46
    v_fmac_f32 v6, v63, v47
    s_nop 1
    v_mfma_f32_16x16x4_f32 v[24:27], v6, v4, v[12:15]
    s_waitcnt lgkmcnt(0)
    s_add_u32 m0, s54, 4096
    s_waitcnt vmcnt(9)
    buffer_load_dwordx4 v164, s[20:23], s36 offen offset:0 nt lds
    v_mfma_f32_16x16x32_bf16 v[8:11], v[148:151], v[148:151], 0
    v_mfma_f32_16x16x32_bf16 v[8:11], v[152:155], v[152:155], v[8:11]
    v_mfma_f32_16x16x32_bf16 v[8:11], v[156:159], v[156:159], v[8:11]
    v_mfma_f32_16x16x32_bf16 v[8:11], v[160:163], v[160:163], v[8:11]
    v_mfma_f32_16x16x32_bf16 v[48:51], v[64:67], v[148:151], 0
    v_mfma_f32_16x16x32_bf16 v[48:51], v[68:71], v[152:155], v[48:51]
    v_mfma_f32_16x16x32_bf16 v[48:51], v[72:75], v[156:159], v[48:51]
    v_mfma_f32_16x16x32_bf16 v[48:51], v[76:79], v[160:163], v[48:51]
    v_mfma_f32_16x16x32_bf16 v[52:55], v[80:83], v[148:151], 0
    v_mfma_f32_16x16x32_bf16 v[52:55], v[84:87], v[152:155], v[52:55]
    v_mfma_f32_16x16x32_bf16 v[52:55], v[88:91], v[156:159], v[52:55]
    v_mfma_f32_16x16x32_bf16 v[52:55], v[92:95], v[160:163], v[52:55]
    s_waitcnt vmcnt(9)
    buffer_load_dwordx4 v165, s[20:23], s36 offen offset:1024 nt lds
    v_cndmask_b32 v7, 0, v8, s[46:47]
    v_cndmask_b32 v7, v7, v9, s[48:49]
    v_cndmask_b32 v7, v7, v10, s[50:51]
    v_cndmask_b32 v7, v7, v11, s[52:53]
    v_mfma_f32_16x16x32_bf16 v[56:59], v[96:99], v[148:151], 0
    v_mfma_f32_16x16x32_bf16 v[56:59], v[100:103], v[152:155], v[56:59]
    v_mfma_f32_16x16x4_f32 v[8:11], v3, v7, 0
    v_mfma_f32_16x16x32_bf16 v[56:59], v[104:107], v[156:159], v[56:59]
    v_mfma_f32_16x16x32_bf16 v[56:59], v[108:111], v[160:163], v[56:59]
    v_cvt_pk_bf16_f32 v24, v24, v24
    v_cvt_pk_bf16_f32 v25, v25, v25
    v_cvt_pk_bf16_f32 v26, v26, v26
    v_cvt_pk_bf16_f32 v27, v27, v27
    ds_write_b128 v128, v[24:27] offset:0
    v_mfma_f32_16x16x32_bf16 v[60:63], v[112:115], v[148:151], 0
    v_mfma_f32_16x16x32_bf16 v[60:63], v[116:119], v[152:155], v[60:63]
    v_mfma_f32_16x16x32_bf16 v[60:63], v[120:123], v[156:159], v[60:63]
    v_mfma_f32_16x16x32_bf16 v[60:63], v[124:127], v[160:163], v[60:63]
    s_waitcnt vmcnt(9)
    buffer_load_dwordx4 v166, s[20:23], s36 offen offset:2048 nt lds
    s_waitcnt vmcnt(11)
    ds_read_b128 v[132:135], v168 offset:8192
    ds_read_b128 v[136:139], v169 offset:8192
    ds_read_b128 v[140:143], v170 offset:8192
    ds_read_b128 v[144:147], v171 offset:8192
    v_fma_f32 v48, v48, s38, v8
    v_fma_f32 v49, v49, s38, v8
    v_exp_f32 v48, v48
    v_exp_f32 v49, v49
    v_mul_f32 v6, v48, v32
    v_fmac_f32 v6, v49, v33
    v_fma_f32 v50, v50, s38, v8
    v_fma_f32 v51, v51, s38, v8
    v_exp_f32 v50, v50
    v_exp_f32 v51, v51
    v_fmac_f32 v6, v50, v34
    v_fmac_f32 v6, v51, v35
    v_fma_f32 v52, v52, s38, v8
    v_fma_f32 v53, v53, s38, v8
    v_exp_f32 v52, v52
    v_exp_f32 v53, v53
    v_fmac_f32 v6, v52, v36
    v_fmac_f32 v6, v53, v37
    v_fma_f32 v54, v54, s38, v8
    v_fma_f32 v55, v55, s38, v8
    v_exp_f32 v54, v54
    v_exp_f32 v55, v55
    v_fmac_f32 v6, v54, v38
    v_fmac_f32 v6, v55, v39
    s_waitcnt vmcnt(9)
    buffer_load_dwordx4 v167, s[20:23], s36 offen offset:3072 nt lds
    s_add_u32 s36, s36, 16384
    v_fma_f32 v56, v56, s38, v8
    v_fma_f32 v57, v57, s38, v8
    v_exp_f32 v56, v56
    v_exp_f32 v57, v57
    v_fmac_f32 v6, v56, v40
    v_fmac_f32 v6, v57, v41
    v_fma_f32 v58, v58, s38, v8
    v_fma_f32 v59, v59, s38, v8
    v_exp_f32 v58, v58
    v_exp_f32 v59, v59
    v_fmac_f32 v6, v58, v42
    v_fmac_f32 v6, v59, v43
    v_fma_f32 v60, v60, s38, v8
    v_fma_f32 v61, v61, s38, v8
    v_exp_f32 v60, v60
    v_exp_f32 v61, v61
    v_fmac_f32 v6, v60, v44
    v_fmac_f32 v6, v61, v45
    v_fma_f32 v62, v62, s38, v8
    v_fma_f32 v63, v63, s38, v8
    v_exp_f32 v62, v62
    v_exp_f32 v63, v63
    v_fmac_f32 v6, v62, v46
    v_fmac_f32 v6, v63, v47
    s_nop 1
    v_mfma_f32_16x16x4_f32 v[24:27], v6, v4, v[12:15]
    s_waitcnt lgkmcnt(0)
    s_add_u32 m0, s54, 8192
    s_waitcnt vmcnt(9)
    buffer_load_dwordx4 v164, s[20:23], s36 offen offset:0 nt lds
    v_mfma_f32_16x16x32_bf16 v[8:11], v[132:135], v[132:135], 0
    v_mfma_f32_16x16x32_bf16 v[8:11], v[136:139], v[136:139], v[8:11]
    v_mfma_f32_16x16x32_bf16 v[8:11], v[140:143], v[140:143], v[8:11]
    v_mfma_f32_16x16x32_bf16 v[8:11], v[144:147], v[144:147], v[8:11]
    v_mfma_f32_16x16x32_bf16 v[48:51], v[64:67], v[132:135], 0
    v_mfma_f32_16x16x32_bf16 v[48:51], v[68:71], v[136:139], v[48:51]
    v_mfma_f32_16x16x32_bf16 v[48:51], v[72:75], v[140:143], v[48:51]
    v_mfma_f32_16x16x32_bf16 v[48:51], v[76:79], v[144:147], v[48:51]
    v_mfma_f32_16x16x32_bf16 v[52:55], v[80:83], v[132:135], 0
    v_mfma_f32_16x16x32_bf16 v[52:55], v[84:87], v[136:139], v[52:55]
    v_mfma_f32_16x16x32_bf16 v[52:55], v[88:91], v[140:143], v[52:55]
    v_mfma_f32_16x16x32_bf16 v[52:55], v[92:95], v[144:147], v[52:55]
    s_waitcnt vmcnt(9)
    buffer_load_dwordx4 v165, s[20:23], s36 offen offset:1024 nt lds
    v_cndmask_b32 v7, 0, v8, s[46:47]
    v_cndmask_b32 v7, v7, v9, s[48:49]
    v_cndmask_b32 v7, v7, v10, s[50:51]
    v_cndmask_b32 v7, v7, v11, s[52:53]
    v_mfma_f32_16x16x32_bf16 v[56:59], v[96:99], v[132:135], 0
    v_mfma_f32_16x16x32_bf16 v[56:59], v[100:103], v[136:139], v[56:59]
    v_mfma_f32_16x16x4_f32 v[8:11], v3, v7, 0
    v_mfma_f32_16x16x32_bf16 v[56:59], v[104:107], v[140:143], v[56:59]
    v_mfma_f32_16x16x32_bf16 v[56:59], v[108:111], v[144:147], v[56:59]
    v_cvt_pk_bf16_f32 v24, v24, v24
    v_cvt_pk_bf16_f32 v25, v25, v25
    v_cvt_pk_bf16_f32 v26, v26, v26
    v_cvt_pk_bf16_f32 v27, v27, v27
    ds_write_b128 v128, v[24:27] offset:64
    v_mfma_f32_16x16x32_bf16 v[60:63], v[112:115], v[132:135], 0
    v_mfma_f32_16x16x32_bf16 v[60:63], v[116:119], v[136:139], v[60:63]
    v_mfma_f32_16x16x32_bf16 v[60:63], v[120:123], v[140:143], v[60:63]
    v_mfma_f32_16x16x32_bf16 v[60:63], v[124:127], v[144:147], v[60:63]
    s_waitcnt vmcnt(9)
    buffer_load_dwordx4 v166, s[20:23], s36 offen offset:2048 nt lds
    s_waitcnt vmcnt(11)
    ds_read_b128 v[148:151], v168 offset:12288
    ds_read_b128 v[152:155], v169 offset:12288
    ds_read_b128 v[156:159], v170 offset:12288
    ds_read_b128 v[160:163], v171 offset:12288
    v_fma_f32 v48, v48, s38, v8
    v_fma_f32 v49, v49, s38, v8
    v_exp_f32 v48, v48
    v_exp_f32 v49, v49
    v_mul_f32 v6, v48, v32
    v_fmac_f32 v6, v49, v33
    v_fma_f32 v50, v50, s38, v8
    v_fma_f32 v51, v51, s38, v8
    v_exp_f32 v50, v50
    v_exp_f32 v51, v51
    v_fmac_f32 v6, v50, v34
    v_fmac_f32 v6, v51, v35
    v_fma_f32 v52, v52, s38, v8
    v_fma_f32 v53, v53, s38, v8
    v_exp_f32 v52, v52
    v_exp_f32 v53, v53
    v_fmac_f32 v6, v52, v36
    v_fmac_f32 v6, v53, v37
    v_fma_f32 v54, v54, s38, v8
    v_fma_f32 v55, v55, s38, v8
    v_exp_f32 v54, v54
    v_exp_f32 v55, v55
    v_fmac_f32 v6, v54, v38
    v_fmac_f32 v6, v55, v39
    s_waitcnt vmcnt(9)
    buffer_load_dwordx4 v167, s[20:23], s36 offen offset:3072 nt lds
    s_add_u32 s36, s36, 16384
    v_fma_f32 v56, v56, s38, v8
    v_fma_f32 v57, v57, s38, v8
    v_exp_f32 v56, v56
    v_exp_f32 v57, v57
    v_fmac_f32 v6, v56, v40
    v_fmac_f32 v6, v57, v41
    v_fma_f32 v58, v58, s38, v8
    v_fma_f32 v59, v59, s38, v8
    v_exp_f32 v58, v58
    v_exp_f32 v59, v59
    v_fmac_f32 v6, v58, v42
    v_fmac_f32 v6, v59, v43
    v_fma_f32 v60, v60, s38, v8
    v_fma_f32 v61, v61, s38, v8
    v_exp_f32 v60, v60
    v_exp_f32 v61, v61
    v_fmac_f32 v6, v60, v44
    v_fmac_f32 v6, v61, v45
    v_fma_f32 v62, v62, s38, v8
    v_fma_f32 v63, v63, s38, v8
    v_exp_f32 v62, v62
    v_exp_f32 v63, v63
    v_fmac_f32 v6, v62, v46
    v_fmac_f32 v6, v63, v47
    s_nop 1
    v_mfma_f32_16x16x4_f32 v[24:27], v6, v4, v[12:15]
    s_waitcnt lgkmcnt(0)
    s_add_u32 m0, s54, 12288
    s_waitcnt vmcnt(9)
    buffer_load_dwordx4 v164, s[20:23], s36 offen offset:0 nt lds
    v_mfma_f32_16x16x32_bf16 v[8:11], v[148:151], v[148:151], 0
    v_mfma_f32_16x16x32_bf16 v[8:11], v[152:155], v[152:155], v[8:11]
    v_mfma_f32_16x16x32_bf16 v[8:11], v[156:159], v[156:159], v[8:11]
    v_mfma_f32_16x16x32_bf16 v[8:11], v[160:163], v[160:163], v[8:11]
    v_mfma_f32_16x16x32_bf16 v[48:51], v[64:67], v[148:151], 0
    v_mfma_f32_16x16x32_bf16 v[48:51], v[68:71], v[152:155], v[48:51]
    v_mfma_f32_16x16x32_bf16 v[48:51], v[72:75], v[156:159], v[48:51]
    v_mfma_f32_16x16x32_bf16 v[48:51], v[76:79], v[160:163], v[48:51]
    v_mfma_f32_16x16x32_bf16 v[52:55], v[80:83], v[148:151], 0
    v_mfma_f32_16x16x32_bf16 v[52:55], v[84:87], v[152:155], v[52:55]
    v_mfma_f32_16x16x32_bf16 v[52:55], v[88:91], v[156:159], v[52:55]
    v_mfma_f32_16x16x32_bf16 v[52:55], v[92:95], v[160:163], v[52:55]
    s_waitcnt vmcnt(9)
    buffer_load_dwordx4 v165, s[20:23], s36 offen offset:1024 nt lds
    v_cndmask_b32 v7, 0, v8, s[46:47]
    v_cndmask_b32 v7, v7, v9, s[48:49]
    v_cndmask_b32 v7, v7, v10, s[50:51]
    v_cndmask_b32 v7, v7, v11, s[52:53]
    v_mfma_f32_16x16x32_bf16 v[56:59], v[96:99], v[148:151], 0
    v_mfma_f32_16x16x32_bf16 v[56:59], v[100:103], v[152:155], v[56:59]
    v_mfma_f32_16x16x4_f32 v[8:11], v3, v7, 0
    v_mfma_f32_16x16x32_bf16 v[56:59], v[104:107], v[156:159], v[56:59]
    v_mfma_f32_16x16x32_bf16 v[56:59], v[108:111], v[160:163], v[56:59]
    v_cvt_pk_bf16_f32 v24, v24, v24
    v_cvt_pk_bf16_f32 v25, v25, v25
    v_cvt_pk_bf16_f32 v26, v26, v26
    v_cvt_pk_bf16_f32 v27, v27, v27
    ds_write_b128 v128, v[24:27] offset:128
    v_mfma_f32_16x16x32_bf16 v[60:63], v[112:115], v[148:151], 0
    v_mfma_f32_16x16x32_bf16 v[60:63], v[116:119], v[152:155], v[60:63]
    v_mfma_f32_16x16x32_bf16 v[60:63], v[120:123], v[156:159], v[60:63]
    v_mfma_f32_16x16x32_bf16 v[60:63], v[124:127], v[160:163], v[60:63]
    s_waitcnt vmcnt(9)
    buffer_load_dwordx4 v166, s[20:23], s36 offen offset:2048 nt lds
    s_waitcnt vmcnt(11)
    ds_read_b128 v[132:135], v168 offset:0
    ds_read_b128 v[136:139], v169 offset:0
    ds_read_b128 v[140:143], v170 offset:0
    ds_read_b128 v[144:147], v171 offset:0
    v_fma_f32 v48, v48, s38, v8
    v_fma_f32 v49, v49, s38, v8
    v_exp_f32 v48, v48
    v_exp_f32 v49, v49
    v_mul_f32 v6, v48, v32
    v_fmac_f32 v6, v49, v33
    v_fma_f32 v50, v50, s38, v8
    v_fma_f32 v51, v51, s38, v8
    v_exp_f32 v50, v50
    v_exp_f32 v51, v51
    v_fmac_f32 v6, v50, v34
    v_fmac_f32 v6, v51, v35
    v_fma_f32 v52, v52, s38, v8
    v_fma_f32 v53, v53, s38, v8
    v_exp_f32 v52, v52
    v_exp_f32 v53, v53
    v_fmac_f32 v6, v52, v36
    v_fmac_f32 v6, v53, v37
    v_fma_f32 v54, v54, s38, v8
    v_fma_f32 v55, v55, s38, v8
    v_exp_f32 v54, v54
    v_exp_f32 v55, v55
    v_fmac_f32 v6, v54, v38
    v_fmac_f32 v6, v55, v39
    s_waitcnt vmcnt(9)
    buffer_load_dwordx4 v167, s[20:23], s36 offen offset:3072 nt lds
    s_add_u32 s36, s36, s37
    v_fma_f32 v56, v56, s38, v8
    v_fma_f32 v57, v57, s38, v8
    v_exp_f32 v56, v56
    v_exp_f32 v57, v57
    v_fmac_f32 v6, v56, v40
    v_fmac_f32 v6, v57, v41
    v_fma_f32 v58, v58, s38, v8
    v_fma_f32 v59, v59, s38, v8
    v_exp_f32 v58, v58
    v_exp_f32 v59, v59
    v_fmac_f32 v6, v58, v42
    v_fmac_f32 v6, v59, v43
    v_fma_f32 v60, v60, s38, v8
    v_fma_f32 v61, v61, s38, v8
    v_exp_f32 v60, v60
    v_exp_f32 v61, v61
    v_fmac_f32 v6, v60, v44
    v_fmac_f32 v6, v61, v45
    v_fma_f32 v62, v62, s38, v8
    v_fma_f32 v63, v63, s38, v8
    v_exp_f32 v62, v62
    v_exp_f32 v63, v63
    v_fmac_f32 v6, v62, v46
    v_fmac_f32 v6, v63, v47
    s_nop 1
    v_mfma_f32_16x16x4_f32 v[24:27], v6, v4, v[12:15]
.p2align 6
L_kloop:
    s_waitcnt lgkmcnt(0)
    s_add_u32 m0, s54, 0
    s_waitcnt vmcnt(5)
    s_cbranch_vccnz L_g1
    s_waitcnt vmcnt(4)
L_g1:
    buffer_load_dwordx4 v164, s[20:23], s36 offen offset:0 nt lds
    v_mfma_f32_16x16x32_bf16 v[8:11], v[132:135], v[132:135], 0
    v_mfma_f32_16x16x32_bf16 v[8:11], v[136:139], v[136:139], v[8:11]
    v_mfma_f32_16x16x32_bf16 v[8:11], v[140:143], v[140:143], v[8:11]
    v_mfma_f32_16x16x32_bf16 v[8:11], v[144:147], v[144:147], v[8:11]
    v_mfma_f32_16x16x32_bf16 v[48:51], v[64:67], v[132:135], 0
    v_mfma_f32_16x16x32_bf16 v[48:51], v[68:71], v[136:139], v[48:51]
    v_mfma_f32_16x16x32_bf16 v[48:51], v[72:75], v[140:143], v[48:51]
    v_mfma_f32_16x16x32_bf16 v[48:51], v[76:79], v[144:147], v[48:51]
    v_mfma_f32_16x16x32_bf16 v[52:55], v[80:83], v[132:135], 0
    v_mfma_f32_16x16x32_bf16 v[52:55], v[84:87], v[136:139], v[52:55]
    v_mfma_f32_16x16x32_bf16 v[52:55], v[88:91], v[140:143], v[52:55]
    v_mfma_f32_16x16x32_bf16 v[52:55], v[92:95], v[144:147], v[52:55]
    s_waitcnt vmcnt(4)
    buffer_load_dwordx4 v165, s[20:23], s36 offen offset:1024 nt lds
    v_cndmask_b32 v7, 0, v8, s[46:47]
    v_cndmask_b32 v7, v7, v9, s[48:49]
    v_cndmask_b32 v7, v7, v10, s[50:51]
    v_cndmask_b32 v7, v7, v11, s[52:53]
    v_mfma_f32_16x16x32_bf16 v[56:59], v[96:99], v[132:135], 0
    v_mfma_f32_16x16x32_bf16 v[56:59], v[100:103], v[136:139], v[56:59]
    v_mfma_f32_16x16x4_f32 v[8:11], v3, v7, 0
    v_mfma_f32_16x16x32_bf16 v[56:59], v[104:107], v[140:143], v[56:59]
    v_mfma_f32_16x16x32_bf16 v[56:59], v[108:111], v[144:147], v[56:59]
    v_cvt_pk_bf16_f32 v24, v24, v24
    v_cvt_pk_bf16_f32 v25, v25, v25
    v_cvt_pk_bf16_f32 v26, v26, v26
    v_cvt_pk_bf16_f32 v27, v27, v27
    ds_write_b128 v128, v[24:27] offset:192
    v_add_u32 v128, 256, v128
    v_mfma_f32_16x16x32_bf16 v[60:63], v[112:115], v[132:135], 0
    v_mfma_f32_16x16x32_bf16 v[60:63], v[116:119], v[136:139], v[60:63]
    v_mfma_f32_16x16x32_bf16 v[60:63], v[120:123], v[140:143], v[60:63]
    v_mfma_f32_16x16x32_bf16 v[60:63], v[124:127], v[144:147], v[60:63]
    s_waitcnt vmcnt(4)
    buffer_load_dwordx4 v166, s[20:23], s36 offen offset:2048 nt lds
    s_waitcnt vmcnt(11)
    ds_read_b128 v[148:151], v168 offset:4096
    ds_read_b128 v[152:155], v169 offset:4096
    ds_read_b128 v[156:159], v170 offset:4096
    ds_read_b128 v[160:163], v171 offset:4096
    v_fma_f32 v48, v48, s38, v8
    v_fma_f32 v49, v49, s38, v8
    v_exp_f32 v48, v48
    v_exp_f32 v49, v49
    v_mul_f32 v6, v48, v32
    v_fmac_f32 v6, v49, v33
    v_fma_f32 v50, v50, s38, v8
    v_fma_f32 v51, v51, s38, v8
    v_exp_f32 v50, v50
    v_exp_f32 v51, v51
    v_fmac_f32 v6, v50, v34
    v_fmac_f32 v6, v51, v35
    v_fma_f32 v52, v52, s38, v8
    v_fma_f32 v53, v53, s38, v8
    v_exp_f32 v52, v52
    v_exp_f32 v53, v53
    v_fmac_f32 v6, v52, v36
    v_fmac_f32 v6, v53, v37
    v_fma_f32 v54, v54, s38, v8
    v_fma_f32 v55, v55, s38, v8
    v_exp_f32 v54, v54
    v_exp_f32 v55, v55
    v_fmac_f32 v6, v54, v38
    v_fmac_f32 v6, v55, v39
    s_waitcnt vmcnt(4)
    buffer_load_dwordx4 v167, s[20:23], s36 offen offset:3072 nt lds
    s_add_u32 s36, s36, 16384
    v_fma_f32 v56, v56, s38, v8
    v_fma_f32 v57, v57, s38, v8
    v_exp_f32 v56, v56
    v_exp_f32 v57, v57
    v_fmac_f32 v6, v56, v40
    v_fmac_f32 v6, v57, v41
    v_fma_f32 v58, v58, s38, v8
    v_fma_f32 v59, v59, s38, v8
    v_exp_f32 v58, v58
    v_exp_f32 v59, v59
    v_fmac_f32 v6, v58, v42
    v_fmac_f32 v6, v59, v43
    v_fma_f32 v60, v60, s38, v8
    v_fma_f32 v61, v61, s38, v8
    v_exp_f32 v60, v60
    v_exp_f32 v61, v61
    v_fmac_f32 v6, v60, v44
    v_fmac_f32 v6, v61, v45
    v_fma_f32 v62, v62, s38, v8
    v_fma_f32 v63, v63, s38, v8
    v_exp_f32 v62, v62
    v_exp_f32 v63, v63
    v_fmac_f32 v6, v62, v46
    v_fmac_f32 v6, v63, v47
    s_nop 1
    v_mfma_f32_16x16x4_f32 v[24:27], v6, v4, v[12:15]
    s_waitcnt lgkmcnt(0)
    s_add_u32 m0, s54, 4096
    s_waitcnt vmcnt(5)
    s_cbranch_vccnz L_g2
    s_waitcnt vmcnt(4)
L_g2:
    buffer_load_dwordx4 v164, s[20:23], s36 offen offset:0 nt lds
    v_mfma_f32_16x16x32_bf16 v[8:11], v[148:151], v[148:151], 0
    v_mfma_f32_16x16x32_bf16 v[8:11], v[152:155], v[152:155], v[8:11]
    v_mfma_f32_16x16x32_bf16 v[8:11], v[156:159], v[156:159], v[8:11]
    v_mfma_f32_16x16x32_bf16 v[8:11], v[160:163], v[160:163], v[8:11]
    v_mfma_f32_16x16x32_bf16 v[48:51], v[64:67], v[148:151], 0
    v_mfma_f32_16x16x32_bf16 v[48:51], v[68:71], v[152:155], v[48:51]
    v_mfma_f32_16x16x32_bf16 v[48:51], v[72:75], v[156:159], v[48:51]
    v_mfma_f32_16x16x32_bf16 v[48:51], v[76:79], v[160:163], v[48:51]
    v_mfma_f32_16x16x32_bf16 v[52:55], v[80:83], v[148:151], 0
    v_mfma_f32_16x16x32_bf16 v[52:55], v[84:87], v[152:155], v[52:55]
    v_mfma_f32_16x16x32_bf16 v[52:55], v[88:91], v[156:159], v[52:55]
    v_mfma_f32_16x16x32_bf16 v[52:55], v[92:95], v[160:163], v[52:55]
    s_waitcnt vmcnt(4)
    buffer_load_dwordx4 v165, s[20:23], s36 offen offset:1024 nt lds
    v_cndmask_b32 v7, 0, v8, s[46:47]
    v_cndmask_b32 v7, v7, v9, s[48:49]
    v_cndmask_b32 v7, v7, v10, s[50:51]
    v_cndmask_b32 v7, v7, v11, s[52:53]
    v_mfma_f32_16x16x32_bf16 v[56:59], v[96:99], v[148:151], 0
    v_mfma_f32_16x16x32_bf16 v[56:59], v[100:103], v[152:155], v[56:59]
    v_mfma_f32_16x16x4_f32 v[8:11], v3, v7, 0
    v_mfma_f32_16x16x32_bf16 v[56:59], v[104:107], v[156:159], v[56:59]
    v_mfma_f32_16x16x32_bf16 v[56:59], v[108:111], v[160:163], v[56:59]
    v_cvt_pk_bf16_f32 v24, v24, v24
    v_cvt_pk_bf16_f32 v25, v25, v25
    v_cvt_pk_bf16_f32 v26, v26, v26
    v_cvt_pk_bf16_f32 v27, v27, v27
    ds_write_b128 v128, v[24:27] offset:0
    v_mfma_f32_16x16x32_bf16 v[60:63], v[112:115], v[148:151], 0
    v_mfma_f32_16x16x32_bf16 v[60:63], v[116:119], v[152:155], v[60:63]
    v_mfma_f32_16x16x32_bf16 v[60:63], v[120:123], v[156:159], v[60:63]
    v_mfma_f32_16x16x32_bf16 v[60:63], v[124:127], v[160:163], v[60:63]
    s_waitcnt vmcnt(4)
    buffer_load_dwordx4 v166, s[20:23], s36 offen offset:2048 nt lds
    s_waitcnt vmcnt(11)
    ds_read_b128 v[132:135], v168 offset:8192
    ds_read_b128 v[136:139], v169 offset:8192
    ds_read_b128 v[140:143], v170 offset:8192
    ds_read_b128 v[144:147], v171 offset:8192
    v_fma_f32 v48, v48, s38, v8
    v_fma_f32 v49, v49, s38, v8
    v_exp_f32 v48, v48
    v_exp_f32 v49, v49
    v_mul_f32 v6, v48, v32
    v_fmac_f32 v6, v49, v33
    v_fma_f32 v50, v50, s38, v8
    v_fma_f32 v51, v51, s38, v8
    v_exp_f32 v50, v50
    v_exp_f32 v51, v51
    v_fmac_f32 v6, v50, v34
    v_fmac_f32 v6, v51, v35
    v_fma_f32 v52, v52, s38, v8
    v_fma_f32 v53, v53, s38, v8
    v_exp_f32 v52, v52
    v_exp_f32 v53, v53
    v_fmac_f32 v6, v52, v36
    v_fmac_f32 v6, v53, v37
    v_fma_f32 v54, v54, s38, v8
    v_fma_f32 v55, v55, s38, v8
    v_exp_f32 v54, v54
    v_exp_f32 v55, v55
    v_fmac_f32 v6, v54, v38
    v_fmac_f32 v6, v55, v39
    s_waitcnt vmcnt(4)
    buffer_load_dwordx4 v167, s[20:23], s36 offen offset:3072 nt lds
    s_add_u32 s36, s36, 16384
    v_fma_f32 v56, v56, s38, v8
    v_fma_f32 v57, v57, s38, v8
    v_exp_f32 v56, v56
    v_exp_f32 v57, v57
    v_fmac_f32 v6, v56, v40
    v_fmac_f32 v6, v57, v41
    v_fma_f32 v58, v58, s38, v8
    v_fma_f32 v59, v59, s38, v8
    v_exp_f32 v58, v58
    v_exp_f32 v59, v59
    v_fmac_f32 v6, v58, v42
    v_fmac_f32 v6, v59, v43
    v_fma_f32 v60, v60, s38, v8
    v_fma_f32 v61, v61, s38, v8
    v_exp_f32 v60, v60
    v_exp_f32 v61, v61
    v_fmac_f32 v6, v60, v44
    v_fmac_f32 v6, v61, v45
    v_fma_f32 v62, v62, s38, v8
    v_fma_f32 v63, v63, s38, v8
    v_exp_f32 v62, v62
    v_exp_f32 v63, v63
    v_fmac_f32 v6, v62, v46
    v_fmac_f32 v6, v63, v47
    s_nop 1
    v_mfma_f32_16x16x4_f32 v[24:27], v6, v4, v[12:15]
    s_waitcnt lgkmcnt(0)
    s_add_u32 m0, s54, 8192
    s_waitcnt vmcnt(5)
    s_cbranch_vccnz L_g3
    s_waitcnt vmcnt(4)
L_g3:
    buffer_load_dwordx4 v164, s[20:23], s36 offen offset:0 nt lds
    v_mfma_f32_16x16x32_bf16 v[8:11], v[132:135], v[132:135], 0
    v_mfma_f32_16x16x32_bf16 v[8:11], v[136:139], v[136:139], v[8:11]
    v_mfma_f32_16x16x32_bf16 v[8:11], v[140:143], v[140:143], v[8:11]
    v_mfma_f32_16x16x32_bf16 v[8:11], v[144:147], v[144:147], v[8:11]
    v_mfma_f32_16x16x32_bf16 v[48:51], v[64:67], v[132:135], 0
    v_mfma_f32_16x16x32_bf16 v[48:51], v[68:71], v[136:139], v[48:51]
    v_mfma_f32_16x16x32_bf16 v[48:51], v[72:75], v[140:143], v[48:51]
    v_mfma_f32_16x16x32_bf16 v[48:51], v[76:79], v[144:147], v[48:51]
    v_mfma_f32_16x16x32_bf16 v[52:55], v[80:83], v[132:135], 0
    v_mfma_f32_16x16x32_bf16 v[52:55], v[84:87], v[136:139], v[52:55]
    v_mfma_f32_16x16x32_bf16 v[52:55], v[88:91], v[140:143], v[52:55]
    v_mfma_f32_16x16x32_bf16 v[52:55], v[92:95], v[144:147], v[52:55]
    s_waitcnt vmcnt(4)
    buffer_load_dwordx4 v165, s[20:23], s36 offen offset:1024 nt lds
    v_cndmask_b32 v7, 0, v8, s[46:47]
    v_cndmask_b32 v7, v7, v9, s[48:49]
    v_cndmask_b32 v7, v7, v10, s[50:51]
    v_cndmask_b32 v7, v7, v11, s[52:53]
    v_mfma_f32_16x16x32_bf16 v[56:59], v[96:99], v[132:135], 0
    v_mfma_f32_16x16x32_bf16 v[56:59], v[100:103], v[136:139], v[56:59]
    v_mfma_f32_16x16x4_f32 v[8:11], v3, v7, 0
    v_mfma_f32_16x16x32_bf16 v[56:59], v[104:107], v[140:143], v[56:59]
    v_mfma_f32_16x16x32_bf16 v[56:59], v[108:111], v[144:147], v[56:59]
    v_cvt_pk_bf16_f32 v24, v24, v24
    v_cvt_pk_bf16_f32 v25, v25, v25
    v_cvt_pk_bf16_f32 v26, v26, v26
    v_cvt_pk_bf16_f32 v27, v27, v27
    ds_write_b128 v128, v[24:27] offset:64
    v_mfma_f32_16x16x32_bf16 v[60:63], v[112:115], v[132:135], 0
    v_mfma_f32_16x16x32_bf16 v[60:63], v[116:119], v[136:139], v[60:63]
    v_mfma_f32_16x16x32_bf16 v[60:63], v[120:123], v[140:143], v[60:63]
    v_mfma_f32_16x16x32_bf16 v[60:63], v[124:127], v[144:147], v[60:63]
    s_waitcnt vmcnt(4)
    buffer_load_dwordx4 v166, s[20:23], s36 offen offset:2048 nt lds
    s_waitcnt vmcnt(11)
    ds_read_b128 v[148:151], v168 offset:12288
    ds_read_b128 v[152:155], v169 offset:12288
    ds_read_b128 v[156:159], v170 offset:12288
    ds_read_b128 v[160:163], v171 offset:12288
    v_fma_f32 v48, v48, s38, v8
    v_fma_f32 v49, v49, s38, v8
    v_exp_f32 v48, v48
    v_exp_f32 v49, v49
    v_mul_f32 v6, v48, v32
    v_fmac_f32 v6, v49, v33
    v_fma_f32 v50, v50, s38, v8
    v_fma_f32 v51, v51, s38, v8
    v_exp_f32 v50, v50
    v_exp_f32 v51, v51
    v_fmac_f32 v6, v50, v34
    v_fmac_f32 v6, v51, v35
    v_fma_f32 v52, v52, s38, v8
    v_fma_f32 v53, v53, s38, v8
    v_exp_f32 v52, v52
    v_exp_f32 v53, v53
    v_fmac_f32 v6, v52, v36
    v_fmac_f32 v6, v53, v37
    v_fma_f32 v54, v54, s38, v8
    v_fma_f32 v55, v55, s38, v8
    v_exp_f32 v54, v54
    v_exp_f32 v55, v55
    v_fmac_f32 v6, v54, v38
    v_fmac_f32 v6, v55, v39
    s_waitcnt vmcnt(4)
    buffer_load_dwordx4 v167, s[20:23], s36 offen offset:3072 nt lds
    s_add_u32 s36, s36, 16384
    v_fma_f32 v56, v56, s38, v8
    v_fma_f32 v57, v57, s38, v8
    v_exp_f32 v56, v56
    v_exp_f32 v57, v57
    v_fmac_f32 v6, v56, v40
    v_fmac_f32 v6, v57, v41
    v_fma_f32 v58, v58, s38, v8
    v_fma_f32 v59, v59, s38, v8
    v_exp_f32 v58, v58
    v_exp_f32 v59, v59
    v_fmac_f32 v6, v58, v42
    v_fmac_f32 v6, v59, v43
    v_fma_f32 v60, v60, s38, v8
    v_fma_f32 v61, v61, s38, v8
    v_exp_f32 v60, v60
    v_exp_f32 v61, v61
    v_fmac_f32 v6, v60, v44
    v_fmac_f32 v6, v61, v45
    v_fma_f32 v62, v62, s38, v8
    v_fma_f32 v63, v63, s38, v8
    v_exp_f32 v62, v62
    v_exp_f32 v63, v63
    v_fmac_f32 v6, v62, v46
    v_fmac_f32 v6, v63, v47
    s_nop 1
    v_mfma_f32_16x16x4_f32 v[24:27], v6, v4, v[12:15]
    s_waitcnt lgkmcnt(0)
    s_add_u32 m0, s54, 12288
    s_waitcnt vmcnt(5)
    s_cbranch_vccnz L_g4
    s_waitcnt vmcnt(4)
L_g4:
    buffer_load_dwordx4 v164, s[20:23], s36 offen offset:0 nt lds
    v_mfma_f32_16x16x32_bf16 v[8:11], v[148:151], v[148:151], 0
    v_mfma_f32_16x16x32_bf16 v[8:11], v[152:155], v[152:155], v[8:11]
    v_mfma_f32_16x16x32_bf16 v[8:11], v[156:159], v[156:159], v[8:11]
    v_mfma_f32_16x16x32_bf16 v[8:11], v[160:163], v[160:163], v[8:11]
    v_mfma_f32_16x16x32_bf16 v[48:51], v[64:67], v[148:151], 0
    v_mfma_f32_16x16x32_bf16 v[48:51], v[68:71], v[152:155], v[48:51]
    v_mfma_f32_16x16x32_bf16 v[48:51], v[72:75], v[156:159], v[48:51]
    v_mfma_f32_16x16x32_bf16 v[48:51], v[76:79], v[160:163], v[48:51]
    v_mfma_f32_16x16x32_bf16 v[52:55], v[80:83], v[148:151], 0
    v_mfma_f32_16x16x32_bf16 v[52:55], v[84:87], v[152:155], v[52:55]
    v_mfma_f32_16x16x32_bf16 v[52:55], v[88:91], v[156:159], v[52:55]
    v_mfma_f32_16x16x32_bf16 v[52:55], v[92:95], v[160:163], v[52:55]
    s_waitcnt vmcnt(4)
    buffer_load_dwordx4 v165, s[20:23], s36 offen offset:1024 nt lds
    v_cndmask_b32 v7, 0, v8, s[46:47]
    v_cndmask_b32 v7, v7, v9, s[48:49]
    v_cndmask_b32 v7, v7, v10, s[50:51]
    v_cndmask_b32 v7, v7, v11, s[52:53]
    v_mfma_f32_16x16x32_bf16 v[56:59], v[96:99], v[148:151], 0
    v_mfma_f32_16x16x32_bf16 v[56:59], v[100:103], v[152:155], v[56:59]
    v_mfma_f32_16x16x4_f32 v[8:11], v3, v7, 0
    v_mfma_f32_16x16x32_bf16 v[56:59], v[104:107], v[156:159], v[56:59]
    v_mfma_f32_16x16x32_bf16 v[56:59], v[108:111], v[160:163], v[56:59]
    v_cvt_pk_bf16_f32 v24, v24, v24
    v_cvt_pk_bf16_f32 v25, v25, v25
    v_cvt_pk_bf16_f32 v26, v26, v26
    v_cvt_pk_bf16_f32 v27, v27, v27
    ds_write_b128 v128, v[24:27] offset:128
    v_mfma_f32_16x16x32_bf16 v[60:63], v[112:115], v[148:151], 0
    v_mfma_f32_16x16x32_bf16 v[60:63], v[116:119], v[152:155], v[60:63]
    v_mfma_f32_16x16x32_bf16 v[60:63], v[120:123], v[156:159], v[60:63]
    v_mfma_f32_16x16x32_bf16 v[60:63], v[124:127], v[160:163], v[60:63]
    s_waitcnt vmcnt(4)
    buffer_load_dwordx4 v166, s[20:23], s36 offen offset:2048 nt lds
    s_waitcnt vmcnt(11)
    ds_read_b128 v[132:135], v168 offset:0
    ds_read_b128 v[136:139], v169 offset:0
    ds_read_b128 v[140:143], v170 offset:0
    ds_read_b128 v[144:147], v171 offset:0
    v_fma_f32 v48, v48, s38, v8
    v_fma_f32 v49, v49, s38, v8
    v_exp_f32 v48, v48
    v_exp_f32 v49, v49
    v_mul_f32 v6, v48, v32
    v_fmac_f32 v6, v49, v33
    v_fma_f32 v50, v50, s38, v8
    v_fma_f32 v51, v51, s38, v8
    v_exp_f32 v50, v50
    v_exp_f32 v51, v51
    v_fmac_f32 v6, v50, v34
    v_fmac_f32 v6, v51, v35
    v_fma_f32 v52, v52, s38, v8
    v_fma_f32 v53, v53, s38, v8
    v_exp_f32 v52, v52
    v_exp_f32 v53, v53
    v_fmac_f32 v6, v52, v36
    v_fmac_f32 v6, v53, v37
    v_fma_f32 v54, v54, s38, v8
    v_fma_f32 v55, v55, s38, v8
    v_exp_f32 v54, v54
    v_exp_f32 v55, v55
    v_fmac_f32 v6, v54, v38
    v_fmac_f32 v6, v55, v39
    s_waitcnt vmcnt(4)
    buffer_load_dwordx4 v167, s[20:23], s36 offen offset:3072 nt lds
    s_add_u32 s36, s36, s37
    v_fma_f32 v56, v56, s38, v8
    v_fma_f32 v57, v57, s38, v8
    v_exp_f32 v56, v56
    v_exp_f32 v57, v57
    v_fmac_f32 v6, v56, v40
    v_fmac_f32 v6, v57, v41
    v_fma_f32 v58, v58, s38, v8
    v_fma_f32 v59, v59, s38, v8
    v_exp_f32 v58, v58
    v_exp_f32 v59, v59
    v_fmac_f32 v6, v58, v42
    v_fmac_f32 v6, v59, v43
    v_fma_f32 v60, v60, s38, v8
    v_fma_f32 v61, v61, s38, v8
    v_exp_f32 v60, v60
    v_exp_f32 v61, v61
    v_fmac_f32 v6, v60, v44
    v_fmac_f32 v6, v61, v45
    v_fma_f32 v62, v62, s38, v8
    v_fma_f32 v63, v63, s38, v8
    v_exp_f32 v62, v62
    v_exp_f32 v63, v63
    v_fmac_f32 v6, v62, v46
    v_fmac_f32 v6, v63, v47
    s_nop 1
    v_mfma_f32_16x16x4_f32 v[24:27], v6, v4, v[12:15]
    s_sub_u32 s40, s40, 1
    s_cmp_lg_u32 s40, 0
    s_cbranch_scc1 L_kloop
    s_mov_b32 s36, s45
    s_waitcnt lgkmcnt(0)
    s_waitcnt vmcnt(5)
    s_cbranch_vccnz L_g5
    s_waitcnt vmcnt(4)
L_g5:
    buffer_load_dwordx4 a[0:3], v2, s[24:27], s36 offen offset:0 nt
    v_mfma_f32_16x16x32_bf16 v[8:11], v[132:135], v[132:135], 0
    v_mfma_f32_16x16x32_bf16 v[8:11], v[136:139], v[136:139], v[8:11]
    v_mfma_f32_16x16x32_bf16 v[8:11], v[140:143], v[140:143], v[8:11]
    v_mfma_f32_16x16x32_bf16 v[8:11], v[144:147], v[144:147], v[8:11]
    v_mfma_f32_16x16x32_bf16 v[48:51], v[64:67], v[132:135], 0
    v_mfma_f32_16x16x32_bf16 v[48:51], v[68:71], v[136:139], v[48:51]
    v_mfma_f32_16x16x32_bf16 v[48:51], v[72:75], v[140:143], v[48:51]
    v_mfma_f32_16x16x32_bf16 v[48:51], v[76:79], v[144:147], v[48:51]
    v_mfma_f32_16x16x32_bf16 v[52:55], v[80:83], v[132:135], 0
    v_mfma_f32_16x16x32_bf16 v[52:55], v[84:87], v[136:139], v[52:55]
    v_mfma_f32_16x16x32_bf16 v[52:55], v[88:91], v[140:143], v[52:55]
    v_mfma_f32_16x16x32_bf16 v[52:55], v[92:95], v[144:147], v[52:55]
    s_waitcnt vmcnt(4)
    buffer_load_dwordx4 a[4:7], v2, s[24:27], s36 offen offset:1024 nt
    v_cndmask_b32 v7, 0, v8, s[46:47]
    v_cndmask_b32 v7, v7, v9, s[48:49]
    v_cndmask_b32 v7, v7, v10, s[50:51]
    v_cndmask_b32 v7, v7, v11, s[52:53]
    v_mfma_f32_16x16x32_bf16 v[56:59], v[96:99], v[132:135], 0
    v_mfma_f32_16x16x32_bf16 v[56:59], v[100:103], v[136:139], v[56:59]
    v_mfma_f32_16x16x4_f32 v[8:11], v3, v7, 0
    v_mfma_f32_16x16x32_bf16 v[56:59], v[104:107], v[140:143], v[56:59]
    v_mfma_f32_16x16x32_bf16 v[56:59], v[108:111], v[144:147], v[56:59]
    v_cvt_pk_bf16_f32 v24, v24, v24
    v_cvt_pk_bf16_f32 v25, v25, v25
    v_cvt_pk_bf16_f32 v26, v26, v26
    v_cvt_pk_bf16_f32 v27, v27, v27
    ds_write_b128 v128, v[24:27] offset:192
    v_add_u32 v128, 256, v128
    v_mfma_f32_16x16x32_bf16 v[60:63], v[112:115], v[132:135], 0
    v_mfma_f32_16x16x32_bf16 v[60:63], v[116:119], v[136:139], v[60:63]
    v_mfma_f32_16x16x32_bf16 v[60:63], v[120:123], v[140:143], v[60:63]
    v_mfma_f32_16x16x32_bf16 v[60:63], v[124:127], v[144:147], v[60:63]
    s_waitcnt vmcnt(4)
    buffer_load_dwordx4 a[8:11], v2, s[24:27], s36 offen offset:2048 nt
    s_waitcnt vmcnt(11)
    ds_read_b128 v[148:151], v168 offset:4096
    ds_read_b128 v[152:155], v169 offset:4096
    ds_read_b128 v[156:159], v170 offset:4096
    ds_read_b128 v[160:163], v171 offset:4096
    v_fma_f32 v48, v48, s38, v8
    v_fma_f32 v49, v49, s38, v8
    v_exp_f32 v48, v48
    v_exp_f32 v49, v49
    v_mul_f32 v6, v48, v32
    v_fmac_f32 v6, v49, v33
    v_fma_f32 v50, v50, s38, v8
    v_fma_f32 v51, v51, s38, v8
    v_exp_f32 v50, v50
    v_exp_f32 v51, v51
    v_fmac_f32 v6, v50, v34
    v_fmac_f32 v6, v51, v35
    v_fma_f32 v52, v52, s38, v8
    v_fma_f32 v53, v53, s38, v8
    v_exp_f32 v52, v52
    v_exp_f32 v53, v53
    v_fmac_f32 v6, v52, v36
    v_fmac_f32 v6, v53, v37
    v_fma_f32 v54, v54, s38, v8
    v_fma_f32 v55, v55, s38, v8
    v_exp_f32 v54, v54
    v_exp_f32 v55, v55
    v_fmac_f32 v6, v54, v38
    v_fmac_f32 v6, v55, v39
    s_waitcnt vmcnt(4)
    buffer_load_dwordx4 a[12:15], v2, s[24:27], s36 offen offset:3072 nt
    s_add_u32 s36, s36, 16384
    v_fma_f32 v56, v56, s38, v8
    v_fma_f32 v57, v57, s38, v8
    v_exp_f32 v56, v56
    v_exp_f32 v57, v57
    v_fmac_f32 v6, v56, v40
    v_fmac_f32 v6, v57, v41
    v_fma_f32 v58, v58, s38, v8
    v_fma_f32 v59, v59, s38, v8
    v_exp_f32 v58, v58
    v_exp_f32 v59, v59
    v_fmac_f32 v6, v58, v42
    v_fmac_f32 v6, v59, v43
    v_fma_f32 v60, v60, s38, v8
    v_fma_f32 v61, v61, s38, v8
    v_exp_f32 v60, v60
    v_exp_f32 v61, v61
    v_fmac_f32 v6, v60, v44
    v_fmac_f32 v6, v61, v45
    v_fma_f32 v62, v62, s38, v8
    v_fma_f32 v63, v63, s38, v8
    v_exp_f32 v62, v62
    v_exp_f32 v63, v63
    v_fmac_f32 v6, v62, v46
    v_fmac_f32 v6, v63, v47
    s_nop 1
    v_mfma_f32_16x16x4_f32 v[24:27], v6, v4, v[12:15]
    s_waitcnt lgkmcnt(0)
    s_waitcnt vmcnt(5)
    s_cbranch_vccnz L_g6
    s_waitcnt vmcnt(4)
L_g6:
    buffer_load_dwordx4 a[16:19], v2, s[24:27], s36 offen offset:0 nt
    v_mfma_f32_16x16x32_bf16 v[8:11], v[148:151], v[148:151], 0
    v_mfma_f32_16x16x32_bf16 v[8:11], v[152:155], v[152:155], v[8:11]
    v_mfma_f32_16x16x32_bf16 v[8:11], v[156:159], v[156:159], v[8:11]
    v_mfma_f32_16x16x32_bf16 v[8:11], v[160:163], v[160:163], v[8:11]
    v_mfma_f32_16x16x32_bf16 v[48:51], v[64:67], v[148:151], 0
    v_mfma_f32_16x16x32_bf16 v[48:51], v[68:71], v[152:155], v[48:51]
    v_mfma_f32_16x16x32_bf16 v[48:51], v[72:75], v[156:159], v[48:51]
    v_mfma_f32_16x16x32_bf16 v[48:51], v[76:79], v[160:163], v[48:51]
    v_mfma_f32_16x16x32_bf16 v[52:55], v[80:83], v[148:151], 0
    v_mfma_f32_16x16x32_bf16 v[52:55], v[84:87], v[152:155], v[52:55]
    v_mfma_f32_16x16x32_bf16 v[52:55], v[88:91], v[156:159], v[52:55]
    v_mfma_f32_16x16x32_bf16 v[52:55], v[92:95], v[160:163], v[52:55]
    s_waitcnt vmcnt(4)
    buffer_load_dwordx4 a[20:23], v2, s[24:27], s36 offen offset:1024 nt
    v_cndmask_b32 v7, 0, v8, s[46:47]
    v_cndmask_b32 v7, v7, v9, s[48:49]
    v_cndmask_b32 v7, v7, v10, s[50:51]
    v_cndmask_b32 v7, v7, v11, s[52:53]
    v_mfma_f32_16x16x32_bf16 v[56:59], v[96:99], v[148:151], 0
    v_mfma_f32_16x16x32_bf16 v[56:59], v[100:103], v[152:155], v[56:59]
    v_mfma_f32_16x16x4_f32 v[8:11], v3, v7, 0
    v_mfma_f32_16x16x32_bf16 v[56:59], v[104:107], v[156:159], v[56:59]
    v_mfma_f32_16x16x32_bf16 v[56:59], v[108:111], v[160:163], v[56:59]
    v_cvt_pk_bf16_f32 v24, v24, v24
    v_cvt_pk_bf16_f32 v25, v25, v25
    v_cvt_pk_bf16_f32 v26, v26, v26
    v_cvt_pk_bf16_f32 v27, v27, v27
    ds_write_b128 v128, v[24:27] offset:0
    v_mfma_f32_16x16x32_bf16 v[60:63], v[112:115], v[148:151], 0
    v_mfma_f32_16x16x32_bf16 v[60:63], v[116:119], v[152:155], v[60:63]
    v_mfma_f32_16x16x32_bf16 v[60:63], v[120:123], v[156:159], v[60:63]
    v_mfma_f32_16x16x32_bf16 v[60:63], v[124:127], v[160:163], v[60:63]
    s_waitcnt vmcnt(4)
    buffer_load_dwordx4 a[24:27], v2, s[24:27], s36 offen offset:2048 nt
    s_waitcnt vmcnt(11)
    ds_read_b128 v[132:135], v168 offset:8192
    ds_read_b128 v[136:139], v169 offset:8192
    ds_read_b128 v[140:143], v170 offset:8192
    ds_read_b128 v[144:147], v171 offset:8192
    v_fma_f32 v48, v48, s38, v8
    v_fma_f32 v49, v49, s38, v8
    v_exp_f32 v48, v48
    v_exp_f32 v49, v49
    v_mul_f32 v6, v48, v32
    v_fmac_f32 v6, v49, v33
    v_fma_f32 v50, v50, s38, v8
    v_fma_f32 v51, v51, s38, v8
    v_exp_f32 v50, v50
    v_exp_f32 v51, v51
    v_fmac_f32 v6, v50, v34
    v_fmac_f32 v6, v51, v35
    v_fma_f32 v52, v52, s38, v8
    v_fma_f32 v53, v53, s38, v8
    v_exp_f32 v52, v52
    v_exp_f32 v53, v53
    v_fmac_f32 v6, v52, v36
    v_fmac_f32 v6, v53, v37
    v_fma_f32 v54, v54, s38, v8
    v_fma_f32 v55, v55, s38, v8
    v_exp_f32 v54, v54
    v_exp_f32 v55, v55
    v_fmac_f32 v6, v54, v38
    v_fmac_f32 v6, v55, v39
    s_waitcnt vmcnt(4)
    buffer_load_dwordx4 a[28:31], v2, s[24:27], s36 offen offset:3072 nt
    s_add_u32 s36, s36, 16384
    v_fma_f32 v56, v56, s38, v8
    v_fma_f32 v57, v57, s38, v8
    v_exp_f32 v56, v56
    v_exp_f32 v57, v57
    v_fmac_f32 v6, v56, v40
    v_fmac_f32 v6, v57, v41
    v_fma_f32 v58, v58, s38, v8
    v_fma_f32 v59, v59, s38, v8
    v_exp_f32 v58, v58
    v_exp_f32 v59, v59
    v_fmac_f32 v6, v58, v42
    v_fmac_f32 v6, v59, v43
    v_fma_f32 v60, v60, s38, v8
    v_fma_f32 v61, v61, s38, v8
    v_exp_f32 v60, v60
    v_exp_f32 v61, v61
    v_fmac_f32 v6, v60, v44
    v_fmac_f32 v6, v61, v45
    v_fma_f32 v62, v62, s38, v8
    v_fma_f32 v63, v63, s38, v8
    v_exp_f32 v62, v62
    v_exp_f32 v63, v63
    v_fmac_f32 v6, v62, v46
    v_fmac_f32 v6, v63, v47
    s_nop 1
    v_mfma_f32_16x16x4_f32 v[24:27], v6, v4, v[12:15]
    s_waitcnt lgkmcnt(0)
    s_waitcnt vmcnt(5)
    s_cbranch_vccnz L_g7
    s_waitcnt vmcnt(4)
L_g7:
    buffer_load_dwordx4 a[32:35], v2, s[24:27], s36 offen offset:0 nt
    v_mfma_f32_16x16x32_bf16 v[8:11], v[132:135], v[132:135], 0
    v_mfma_f32_16x16x32_bf16 v[8:11], v[136:139], v[136:139], v[8:11]
    v_mfma_f32_16x16x32_bf16 v[8:11], v[140:143], v[140:143], v[8:11]
    v_mfma_f32_16x16x32_bf16 v[8:11], v[144:147], v[144:147], v[8:11]
    v_mfma_f32_16x16x32_bf16 v[48:51], v[64:67], v[132:135], 0
    v_mfma_f32_16x16x32_bf16 v[48:51], v[68:71], v[136:139], v[48:51]
    v_mfma_f32_16x16x32_bf16 v[48:51], v[72:75], v[140:143], v[48:51]
    v_mfma_f32_16x16x32_bf16 v[48:51], v[76:79], v[144:147], v[48:51]
    v_mfma_f32_16x16x32_bf16 v[52:55], v[80:83], v[132:135], 0
    v_mfma_f32_16x16x32_bf16 v[52:55], v[84:87], v[136:139], v[52:55]
    v_mfma_f32_16x16x32_bf16 v[52:55], v[88:91], v[140:143], v[52:55]
    v_mfma_f32_16x16x32_bf16 v[52:55], v[92:95], v[144:147], v[52:55]
    s_waitcnt vmcnt(4)
    buffer_load_dwordx4 a[36:39], v2, s[24:27], s36 offen offset:1024 nt
    v_cndmask_b32 v7, 0, v8, s[46:47]
    v_cndmask_b32 v7, v7, v9, s[48:49]
    v_cndmask_b32 v7, v7, v10, s[50:51]
    v_cndmask_b32 v7, v7, v11, s[52:53]
    v_mfma_f32_16x16x32_bf16 v[56:59], v[96:99], v[132:135], 0
    v_mfma_f32_16x16x32_bf16 v[56:59], v[100:103], v[136:139], v[56:59]
    v_mfma_f32_16x16x4_f32 v[8:11], v3, v7, 0
    v_mfma_f32_16x16x32_bf16 v[56:59], v[104:107], v[140:143], v[56:59]
    v_mfma_f32_16x16x32_bf16 v[56:59], v[108:111], v[144:147], v[56:59]
    v_cvt_pk_bf16_f32 v24, v24, v24
    v_cvt_pk_bf16_f32 v25, v25, v25
    v_cvt_pk_bf16_f32 v26, v26, v26
    v_cvt_pk_bf16_f32 v27, v27, v27
    ds_write_b128 v128, v[24:27] offset:64
    v_mfma_f32_16x16x32_bf16 v[60:63], v[112:115], v[132:135], 0
    v_mfma_f32_16x16x32_bf16 v[60:63], v[116:119], v[136:139], v[60:63]
    v_mfma_f32_16x16x32_bf16 v[60:63], v[120:123], v[140:143], v[60:63]
    v_mfma_f32_16x16x32_bf16 v[60:63], v[124:127], v[144:147], v[60:63]
    s_waitcnt vmcnt(4)
    buffer_load_dwordx4 a[40:43], v2, s[24:27], s36 offen offset:2048 nt
    s_waitcnt vmcnt(11)
    ds_read_b128 v[148:151], v168 offset:12288
    ds_read_b128 v[152:155], v169 offset:12288
    ds_read_b128 v[156:159], v170 offset:12288
    ds_read_b128 v[160:163], v171 offset:12288
    v_fma_f32 v48, v48, s38, v8
    v_fma_f32 v49, v49, s38, v8
    v_exp_f32 v48, v48
    v_exp_f32 v49, v49
    v_mul_f32 v6, v48, v32
    v_fmac_f32 v6, v49, v33
    v_fma_f32 v50, v50, s38, v8
    v_fma_f32 v51, v51, s38, v8
    v_exp_f32 v50, v50
    v_exp_f32 v51, v51
    v_fmac_f32 v6, v50, v34
    v_fmac_f32 v6, v51, v35
    v_fma_f32 v52, v52, s38, v8
    v_fma_f32 v53, v53, s38, v8
    v_exp_f32 v52, v52
    v_exp_f32 v53, v53
    v_fmac_f32 v6, v52, v36
    v_fmac_f32 v6, v53, v37
    v_fma_f32 v54, v54, s38, v8
    v_fma_f32 v55, v55, s38, v8
    v_exp_f32 v54, v54
    v_exp_f32 v55, v55
    v_fmac_f32 v6, v54, v38
    v_fmac_f32 v6, v55, v39
    s_waitcnt vmcnt(4)
    buffer_load_dwordx4 a[44:47], v2, s[24:27], s36 offen offset:3072 nt
    s_add_u32 s36, s36, 16384
    v_fma_f32 v56, v56, s38, v8
    v_fma_f32 v57, v57, s38, v8
    v_exp_f32 v56, v56
    v_exp_f32 v57, v57
    v_fmac_f32 v6, v56, v40
    v_fmac_f32 v6, v57, v41
    v_fma_f32 v58, v58, s38, v8
    v_fma_f32 v59, v59, s38, v8
    v_exp_f32 v58, v58
    v_exp_f32 v59, v59
    v_fmac_f32 v6, v58, v42
    v_fmac_f32 v6, v59, v43
    v_fma_f32 v60, v60, s38, v8
    v_fma_f32 v61, v61, s38, v8
    v_exp_f32 v60, v60
    v_exp_f32 v61, v61
    v_fmac_f32 v6, v60, v44
    v_fmac_f32 v6, v61, v45
    v_fma_f32 v62, v62, s38, v8
    v_fma_f32 v63, v63, s38, v8
    v_exp_f32 v62, v62
    v_exp_f32 v63, v63
    v_fmac_f32 v6, v62, v46
    v_fmac_f32 v6, v63, v47
    s_nop 1
    v_mfma_f32_16x16x4_f32 v[24:27], v6, v4, v[12:15]
    s_waitcnt lgkmcnt(0)
    s_waitcnt vmcnt(5)
    s_cbranch_vccnz L_g8
    s_waitcnt vmcnt(4)
L_g8:
    buffer_load_dwordx4 a[48:51], v2, s[24:27], s36 offen offset:0 nt
    v_mfma_f32_16x16x32_bf16 v[8:11], v[148:151], v[148:151], 0
    v_mfma_f32_16x16x32_bf16 v[8:11], v[152:155], v[152:155], v[8:11]
    v_mfma_f32_16x16x32_bf16 v[8:11], v[156:159], v[156:159], v[8:11]
    v_mfma_f32_16x16x32_bf16 v[8:11], v[160:163], v[160:163], v[8:11]
    v_mfma_f32_16x16x32_bf16 v[48:51], v[64:67], v[148:151], 0
    v_mfma_f32_16x16x32_bf16 v[48:51], v[68:71], v[152:155], v[48:51]
    v_mfma_f32_16x16x32_bf16 v[48:51], v[72:75], v[156:159], v[48:51]
    v_mfma_f32_16x16x32_bf16 v[48:51], v[76:79], v[160:163], v[48:51]
    v_mfma_f32_16x16x32_bf16 v[52:55], v[80:83], v[148:151], 0
    v_mfma_f32_16x16x32_bf16 v[52:55], v[84:87], v[152:155], v[52:55]
    v_mfma_f32_16x16x32_bf16 v[52:55], v[88:91], v[156:159], v[52:55]
    v_mfma_f32_16x16x32_bf16 v[52:55], v[92:95], v[160:163], v[52:55]
    s_waitcnt vmcnt(4)
    buffer_load_dwordx4 a[52:55], v2, s[24:27], s36 offen offset:1024 nt
    v_cndmask_b32 v7, 0, v8, s[46:47]
    v_cndmask_b32 v7, v7, v9, s[48:49]
    v_cndmask_b32 v7, v7, v10, s[50:51]
    v_cndmask_b32 v7, v7, v11, s[52:53]
    v_mfma_f32_16x16x32_bf16 v[56:59], v[96:99], v[148:151], 0
    v_mfma_f32_16x16x32_bf16 v[56:59], v[100:103], v[152:155], v[56:59]
    v_mfma_f32_16x16x4_f32 v[8:11], v3, v7, 0
    v_mfma_f32_16x16x32_bf16 v[56:59], v[104:107], v[156:159], v[56:59]
    v_mfma_f32_16x16x32_bf16 v[56:59], v[108:111], v[160:163], v[56:59]
    v_cvt_pk_bf16_f32 v24, v24, v24
    v_cvt_pk_bf16_f32 v25, v25, v25
    v_cvt_pk_bf16_f32 v26, v26, v26
    v_cvt_pk_bf16_f32 v27, v27, v27
    ds_write_b128 v128, v[24:27] offset:128
    v_mfma_f32_16x16x32_bf16 v[60:63], v[112:115], v[148:151], 0
    v_mfma_f32_16x16x32_bf16 v[60:63], v[116:119], v[152:155], v[60:63]
    v_mfma_f32_16x16x32_bf16 v[60:63], v[120:123], v[156:159], v[60:63]
    v_mfma_f32_16x16x32_bf16 v[60:63], v[124:127], v[160:163], v[60:63]
    s_waitcnt vmcnt(4)
    buffer_load_dwordx4 a[56:59], v2, s[24:27], s36 offen offset:2048 nt
    v_fma_f32 v48, v48, s38, v8
    v_fma_f32 v49, v49, s38, v8
    v_exp_f32 v48, v48
    v_exp_f32 v49, v49
    v_mul_f32 v6, v48, v32
    v_fmac_f32 v6, v49, v33
    v_fma_f32 v50, v50, s38, v8
    v_fma_f32 v51, v51, s38, v8
    v_exp_f32 v50, v50
    v_exp_f32 v51, v51
    v_fmac_f32 v6, v50, v34
    v_fmac_f32 v6, v51, v35
    v_fma_f32 v52, v52, s38, v8
    v_fma_f32 v53, v53, s38, v8
    v_exp_f32 v52, v52
    v_exp_f32 v53, v53
    v_fmac_f32 v6, v52, v36
    v_fmac_f32 v6, v53, v37
    v_fma_f32 v54, v54, s38, v8
    v_fma_f32 v55, v55, s38, v8
    v_exp_f32 v54, v54
    v_exp_f32 v55, v55
    v_fmac_f32 v6, v54, v38
    v_fmac_f32 v6, v55, v39
    s_waitcnt vmcnt(4)
    buffer_load_dwordx4 a[60:63], v2, s[24:27], s36 offen offset:3072 nt
    s_add_u32 s36, s36, s37
    v_fma_f32 v56, v56, s38, v8
    v_fma_f32 v57, v57, s38, v8
    v_exp_f32 v56, v56
    v_exp_f32 v57, v57
    v_fmac_f32 v6, v56, v40
    v_fmac_f32 v6, v57, v41
    v_fma_f32 v58, v58, s38, v8
    v_fma_f32 v59, v59, s38, v8
    v_exp_f32 v58, v58
    v_exp_f32 v59, v59
    v_fmac_f32 v6, v58, v42
    v_fmac_f32 v6, v59, v43
    v_fma_f32 v60, v60, s38, v8
    v_fma_f32 v61, v61, s38, v8
    v_exp_f32 v60, v60
    v_exp_f32 v61, v61
    v_fmac_f32 v6, v60, v44
    v_fmac_f32 v6, v61, v45
    v_fma_f32 v62, v62, s38, v8
    v_fma_f32 v63, v63, s38, v8
    v_exp_f32 v62, v62
    v_exp_f32 v63, v63
    v_fmac_f32 v6, v62, v46
    v_fmac_f32 v6, v63, v47
    s_nop 1
    v_mfma_f32_16x16x4_f32 v[24:27], v6, v4, v[12:15]
    v_mov_b32 v20, 0
    v_mov_b32 v28, 0
    v_mov_b32 v21, 0
    v_mov_b32 v29, 0
    v_mov_b32 v22, 0
    v_mov_b32 v30, 0
    v_mov_b32 v23, 0
    v_mov_b32 v31, 0
    s_mov_b32 s40, 15
    s_nop 0
    v_cvt_pk_bf16_f32 v24, v24, v24
    v_cvt_pk_bf16_f32 v25, v25, v25
    v_cvt_pk_bf16_f32 v26, v26, v26
    v_cvt_pk_bf16_f32 v27, v27, v27
    ds_write_b128 v128, v[24:27] offset:192
    v_subrev_u32 v128, 3840, v128
    v_cmp_lt_u32 s[46:47], 31, v0
    v_mov_b32 v8, 0x3f803f80
    v_mov_b32 v9, 0x3f803f80
    v_mov_b32 v10, 0x3f803f80
    v_mov_b32 v11, 0x3f803f80
    s_waitcnt lgkmcnt(0)
    ds_read_b128 v[32:35], v128
.p2align 6
L_vloop:
    s_waitcnt lgkmcnt(0)
    ds_read_b128 v[36:39], v128 offset:64
    v_and_b32 v48, v32, v16
    v_and_b32 v49, v32, v17
    v_and_b32 v50, v32, v18
    v_and_b32 v51, v32, v19
    v_and_b32 v52, v33, v16
    v_and_b32 v53, v33, v17
    v_and_b32 v54, v33, v18
    v_and_b32 v55, v33, v19
    v_and_b32 v56, v34, v16
    v_and_b32 v57, v34, v17
    v_and_b32 v58, v34, v18
    v_and_b32 v59, v34, v19
    v_and_b32 v60, v35, v16
    v_and_b32 v61, v35, v17
    v_and_b32 v62, v35, v18
    v_and_b32 v63, v35, v19
    v_mfma_f32_16x16x32_bf16 v[28:31], v[48:51], v[8:11], v[28:31]
    v_mfma_f32_16x16x32_bf16 v[28:31], v[52:55], v[8:11], v[28:31]
    v_mfma_f32_16x16x32_bf16 v[28:31], v[56:59], v[8:11], v[28:31]
    v_mfma_f32_16x16x32_bf16 v[28:31], v[60:63], v[8:11], v[28:31]
    s_waitcnt vmcnt(12)
    v_mfma_f32_16x16x32_bf16 v[20:23], v[48:51], a[0:3], v[20:23]
    v_mfma_f32_16x16x32_bf16 v[20:23], v[52:55], a[4:7], v[20:23]
    v_mfma_f32_16x16x32_bf16 v[20:23], v[56:59], a[8:11], v[20:23]
    v_mfma_f32_16x16x32_bf16 v[20:23], v[60:63], a[12:15], v[20:23]
    s_waitcnt vmcnt(5)
    s_cbranch_vccnz L_g9
    s_waitcnt vmcnt(4)
L_g9:
    buffer_load_dwordx4 a[0:3], v2, s[24:27], s36 offen offset:0 nt
    s_waitcnt vmcnt(4)
    buffer_load_dwordx4 a[4:7], v2, s[24:27], s36 offen offset:1024 nt
    s_waitcnt vmcnt(4)
    buffer_load_dwordx4 a[8:11], v2, s[24:27], s36 offen offset:2048 nt
    s_waitcnt vmcnt(4)
    buffer_load_dwordx4 a[12:15], v2, s[24:27], s36 offen offset:3072 nt
    s_add_u32 s36, s36, 16384
    s_waitcnt lgkmcnt(0)
    ds_read_b128 v[32:35], v128 offset:128
    v_and_b32 v48, v36, v16
    v_and_b32 v49, v36, v17
    v_and_b32 v50, v36, v18
    v_and_b32 v51, v36, v19
    v_and_b32 v52, v37, v16
    v_and_b32 v53, v37, v17
    v_and_b32 v54, v37, v18
    v_and_b32 v55, v37, v19
    v_and_b32 v56, v38, v16
    v_and_b32 v57, v38, v17
    v_and_b32 v58, v38, v18
    v_and_b32 v59, v38, v19
    v_and_b32 v60, v39, v16
    v_and_b32 v61, v39, v17
    v_and_b32 v62, v39, v18
    v_and_b32 v63, v39, v19
    v_mfma_f32_16x16x32_bf16 v[28:31], v[48:51], v[8:11], v[28:31]
    v_mfma_f32_16x16x32_bf16 v[28:31], v[52:55], v[8:11], v[28:31]
    v_mfma_f32_16x16x32_bf16 v[28:31], v[56:59], v[8:11], v[28:31]
    v_mfma_f32_16x16x32_bf16 v[28:31], v[60:63], v[8:11], v[28:31]
    s_waitcnt vmcnt(12)
    v_mfma_f32_16x16x32_bf16 v[20:23], v[48:51], a[16:19], v[20:23]
    v_mfma_f32_16x16x32_bf16 v[20:23], v[52:55], a[20:23], v[20:23]
    v_mfma_f32_16x16x32_bf16 v[20:23], v[56:59], a[24:27], v[20:23]
    v_mfma_f32_16x16x32_bf16 v[20:23], v[60:63], a[28:31], v[20:23]
    s_waitcnt vmcnt(5)
    s_cbranch_vccnz L_g10
    s_waitcnt vmcnt(4)
L_g10:
    buffer_load_dwordx4 a[16:19], v2, s[24:27], s36 offen offset:0 nt
    s_waitcnt vmcnt(4)
    buffer_load_dwordx4 a[20:23], v2, s[24:27], s36 offen offset:1024 nt
    s_waitcnt vmcnt(4)
    buffer_load_dwordx4 a[24:27], v2, s[24:27], s36 offen offset:2048 nt
    s_waitcnt vmcnt(4)
    buffer_load_dwordx4 a[28:31], v2, s[24:27], s36 offen offset:3072 nt
    s_add_u32 s36, s36, 16384
    s_waitcnt lgkmcnt(0)
    ds_read_b128 v[36:39], v128 offset:192
    v_and_b32 v48, v32, v16
    v_and_b32 v49, v32, v17
    v_and_b32 v50, v32, v18
    v_and_b32 v51, v32, v19
    v_and_b32 v52, v33, v16
    v_and_b32 v53, v33, v17
    v_and_b32 v54, v33, v18
    v_and_b32 v55, v33, v19
    v_and_b32 v56, v34, v16
    v_and_b32 v57, v34, v17
    v_and_b32 v58, v34, v18
    v_and_b32 v59, v34, v19
    v_and_b32 v60, v35, v16
    v_and_b32 v61, v35, v17
    v_and_b32 v62, v35, v18
    v_and_b32 v63, v35, v19
    v_mfma_f32_16x16x32_bf16 v[28:31], v[48:51], v[8:11], v[28:31]
    v_mfma_f32_16x16x32_bf16 v[28:31], v[52:55], v[8:11], v[28:31]
    v_mfma_f32_16x16x32_bf16 v[28:31], v[56:59], v[8:11], v[28:31]
    v_mfma_f32_16x16x32_bf16 v[28:31], v[60:63], v[8:11], v[28:31]
    s_waitcnt vmcnt(12)
    v_mfma_f32_16x16x32_bf16 v[20:23], v[48:51], a[32:35], v[20:23]
    v_mfma_f32_16x16x32_bf16 v[20:23], v[52:55], a[36:39], v[20:23]
    v_mfma_f32_16x16x32_bf16 v[20:23], v[56:59], a[40:43], v[20:23]
    v_mfma_f32_16x16x32_bf16 v[20:23], v[60:63], a[44:47], v[20:23]
    s_waitcnt vmcnt(5)
    s_cbranch_vccnz L_g11
    s_waitcnt vmcnt(4)
L_g11:
    buffer_load_dwordx4 a[32:35], v2, s[24:27], s36 offen offset:0 nt
    s_waitcnt vmcnt(4)
    buffer_load_dwordx4 a[36:39], v2, s[24:27], s36 offen offset:1024 nt
    s_waitcnt vmcnt(4)
    buffer_load_dwordx4 a[40:43], v2, s[24:27], s36 offen offset:2048 nt
    s_waitcnt vmcnt(4)
    buffer_load_dwordx4 a[44:47], v2, s[24:27], s36 offen offset:3072 nt
    s_add_u32 s36, s36, 16384
    s_waitcnt lgkmcnt(0)
    ds_read_b128 v[32:35], v128 offset:256
    v_and_b32 v48, v36, v16
    v_and_b32 v49, v36, v17
    v_and_b32 v50, v36, v18
    v_and_b32 v51, v36, v19
    v_and_b32 v52, v37, v16
    v_and_b32 v53, v37, v17
    v_and_b32 v54, v37, v18
    v_and_b32 v55, v37, v19
    v_and_b32 v56, v38, v16
    v_and_b32 v57, v38, v17
    v_and_b32 v58, v38, v18
    v_and_b32 v59, v38, v19
    v_and_b32 v60, v39, v16
    v_and_b32 v61, v39, v17
    v_and_b32 v62, v39, v18
    v_and_b32 v63, v39, v19
    v_mfma_f32_16x16x32_bf16 v[28:31], v[48:51], v[8:11], v[28:31]
    v_mfma_f32_16x16x32_bf16 v[28:31], v[52:55], v[8:11], v[28:31]
    v_mfma_f32_16x16x32_bf16 v[28:31], v[56:59], v[8:11], v[28:31]
    v_mfma_f32_16x16x32_bf16 v[28:31], v[60:63], v[8:11], v[28:31]
    s_waitcnt vmcnt(12)
    v_mfma_f32_16x16x32_bf16 v[20:23], v[48:51], a[48:51], v[20:23]
    v_mfma_f32_16x16x32_bf16 v[20:23], v[52:55], a[52:55], v[20:23]
    v_mfma_f32_16x16x32_bf16 v[20:23], v[56:59], a[56:59], v[20:23]
    v_mfma_f32_16x16x32_bf16 v[20:23], v[60:63], a[60:63], v[20:23]
    s_waitcnt vmcnt(5)
    s_cbranch_vccnz L_g12
    s_waitcnt vmcnt(4)
L_g12:
    buffer_load_dwordx4 a[48:51], v2, s[24:27], s36 offen offset:0 nt
    s_waitcnt vmcnt(4)
    buffer_load_dwordx4 a[52:55], v2, s[24:27], s36 offen offset:1024 nt
    s_waitcnt vmcnt(4)
    buffer_load_dwordx4 a[56:59], v2, s[24:27], s36 offen offset:2048 nt
    s_waitcnt vmcnt(4)
    buffer_load_dwordx4 a[60:63], v2, s[24:27], s36 offen offset:3072 nt
    s_add_u32 s36, s36, s37
    v_add_u32 v128, 256, v128
    s_sub_u32 s40, s40, 1
    s_cmp_lg_u32 s40, 0
    s_cbranch_scc1 L_vloop
    v_lshlrev_b32 v6, 3, v0
    v_add_u32 v6, 17408, v6
    v_mov_b32 v7, 17408
    s_lshl_b32 s43, s2, 10
    v_add_u32 v1, s43, v2
    v_xor_b32 v5, 1024, v1
    s_and_b32 s43, s41, 3
    s_lshl_b32 s43, s43, 3
    s_lshl_b32 s44, 1, s43
    v_mov_b32 v3, s44
    s_and_b32 s44, s41, 0xfc
    v_mov_b32 v131, s44
    s_lshl_b32 s44, s41, 8
    v_lshlrev_b32 v130, 2, v0
    v_add_u32 v130, s44, v130
    s_waitcnt lgkmcnt(0)
    ds_read_b128 v[36:39], v128 offset:64
    v_and_b32 v48, v32, v16
    v_and_b32 v49, v32, v17
    v_and_b32 v50, v32, v18
    v_and_b32 v51, v32, v19
    v_and_b32 v52, v33, v16
    v_and_b32 v53, v33, v17
    v_and_b32 v54, v33, v18
    v_and_b32 v55, v33, v19
    v_and_b32 v56, v34, v16
    v_and_b32 v57, v34, v17
    v_and_b32 v58, v34, v18
    v_and_b32 v59, v34, v19
    v_and_b32 v60, v35, v16
    v_and_b32 v61, v35, v17
    v_and_b32 v62, v35, v18
    v_and_b32 v63, v35, v19
    v_mfma_f32_16x16x32_bf16 v[28:31], v[48:51], v[8:11], v[28:31]
    v_mfma_f32_16x16x32_bf16 v[28:31], v[52:55], v[8:11], v[28:31]
    v_mfma_f32_16x16x32_bf16 v[28:31], v[56:59], v[8:11], v[28:31]
    v_mfma_f32_16x16x32_bf16 v[28:31], v[60:63], v[8:11], v[28:31]
    s_waitcnt vmcnt(12)
    v_mfma_f32_16x16x32_bf16 v[20:23], v[48:51], a[0:3], v[20:23]
    v_mfma_f32_16x16x32_bf16 v[20:23], v[52:55], a[4:7], v[20:23]
    v_mfma_f32_16x16x32_bf16 v[20:23], v[56:59], a[8:11], v[20:23]
    v_mfma_f32_16x16x32_bf16 v[20:23], v[60:63], a[12:15], v[20:23]
    s_waitcnt lgkmcnt(0)
    ds_read_b128 v[32:35], v128 offset:128
    v_and_b32 v48, v36, v16
    v_and_b32 v49, v36, v17
    v_and_b32 v50, v36, v18
    v_and_b32 v51, v36, v19
    v_and_b32 v52, v37, v16
    v_and_b32 v53, v37, v17
    v_and_b32 v54, v37, v18
    v_and_b32 v55, v37, v19
    v_and_b32 v56, v38, v16
    v_and_b32 v57, v38, v17
    v_and_b32 v58, v38, v18
    v_and_b32 v59, v38, v19
    v_and_b32 v60, v39, v16
    v_and_b32 v61, v39, v17
    v_and_b32 v62, v39, v18
    v_and_b32 v63, v39, v19
    v_mfma_f32_16x16x32_bf16 v[28:31], v[48:51], v[8:11], v[28:31]
    v_mfma_f32_16x16x32_bf16 v[28:31], v[52:55], v[8:11], v[28:31]
    v_mfma_f32_16x16x32_bf16 v[28:31], v[56:59], v[8:11], v[28:31]
    v_mfma_f32_16x16x32_bf16 v[28:31], v[60:63], v[8:11], v[28:31]
    s_waitcnt vmcnt(8)
    v_mfma_f32_16x16x32_bf16 v[20:23], v[48:51], a[16:19], v[20:23]
    v_mfma_f32_16x16x32_bf16 v[20:23], v[52:55], a[20:23], v[20:23]
    v_mfma_f32_16x16x32_bf16 v[20:23], v[56:59], a[24:27], v[20:23]
    v_mfma_f32_16x16x32_bf16 v[20:23], v[60:63], a[28:31], v[20:23]
    s_waitcnt lgkmcnt(0)
    ds_read_b128 v[36:39], v128 offset:192
    v_and_b32 v48, v32, v16
    v_and_b32 v49, v32, v17
    v_and_b32 v50, v32, v18
    v_and_b32 v51, v32, v19
    v_and_b32 v52, v33, v16
    v_and_b32 v53, v33, v17
    v_and_b32 v54, v33, v18
    v_and_b32 v55, v33, v19
    v_and_b32 v56, v34, v16
    v_and_b32 v57, v34, v17
    v_and_b32 v58, v34, v18
    v_and_b32 v59, v34, v19
    v_and_b32 v60, v35, v16
    v_and_b32 v61, v35, v17
    v_and_b32 v62, v35, v18
    v_and_b32 v63, v35, v19
    v_mfma_f32_16x16x32_bf16 v[28:31], v[48:51], v[8:11], v[28:31]
    v_mfma_f32_16x16x32_bf16 v[28:31], v[52:55], v[8:11], v[28:31]
    v_mfma_f32_16x16x32_bf16 v[28:31], v[56:59], v[8:11], v[28:31]
    v_mfma_f32_16x16x32_bf16 v[28:31], v[60:63], v[8:11], v[28:31]
    s_waitcnt vmcnt(4)
    v_mfma_f32_16x16x32_bf16 v[20:23], v[48:51], a[32:35], v[20:23]
    v_mfma_f32_16x16x32_bf16 v[20:23], v[52:55], a[36:39], v[20:23]
    v_mfma_f32_16x16x32_bf16 v[20:23], v[56:59], a[40:43], v[20:23]
    v_mfma_f32_16x16x32_bf16 v[20:23], v[60:63], a[44:47], v[20:23]
    s_waitcnt lgkmcnt(0)
    v_and_b32 v48, v36, v16
    v_and_b32 v49, v36, v17
    v_and_b32 v50, v36, v18
    v_and_b32 v51, v36, v19
    v_and_b32 v52, v37, v16
    v_and_b32 v53, v37, v17
    v_and_b32 v54, v37, v18
    v_and_b32 v55, v37, v19
    v_and_b32 v56, v38, v16
    v_and_b32 v57, v38, v17
    v_and_b32 v58, v38, v18
    v_and_b32 v59, v38, v19
    v_and_b32 v60, v39, v16
    v_and_b32 v61, v39, v17
    v_and_b32 v62, v39, v18
    v_and_b32 v63, v39, v19
    v_mfma_f32_16x16x32_bf16 v[28:31], v[48:51], v[8:11], v[28:31]
    v_mfma_f32_16x16x32_bf16 v[28:31], v[52:55], v[8:11], v[28:31]
    v_mfma_f32_16x16x32_bf16 v[28:31], v[56:59], v[8:11], v[28:31]
    v_mfma_f32_16x16x32_bf16 v[28:31], v[60:63], v[8:11], v[28:31]
    s_waitcnt vmcnt(0)
    v_mfma_f32_16x16x32_bf16 v[20:23], v[48:51], a[48:51], v[20:23]
    v_mfma_f32_16x16x32_bf16 v[20:23], v[52:55], a[52:55], v[20:23]
    v_mfma_f32_16x16x32_bf16 v[20:23], v[56:59], a[56:59], v[20:23]
    v_mfma_f32_16x16x32_bf16 v[20:23], v[60:63], a[60:63], v[20:23]
    s_nop 7
    v_cndmask_b32 v20, v20, v28, s[46:47]
    ds_write_b128 v129, v[20:23]
    s_waitcnt lgkmcnt(0)
    s_barrier
    s_cmp_lg_u32 s42, 0
    s_cbranch_scc1 L_end
    ds_read_b64 v[48:49], v6 offset:0
    ds_read_b64 v[50:51], v6 offset:16384
    ds_read_b64 v[52:53], v6 offset:32768
    ds_read_b64 v[54:55], v6 offset:49152
    ds_read_b32 v56, v7 offset:512
    ds_read_b32 v57, v7 offset:16896
    ds_read_b32 v58, v7 offset:33280
    ds_read_b32 v59, v7 offset:49664
    s_waitcnt lgkmcnt(0)
    v_add_f32 v20, v48, v50
    v_add_f32 v21, v49, v51
    v_add_f32 v22, v56, v57
    v_add_f32 v20, v20, v52
    v_add_f32 v21, v21, v53
    v_add_f32 v22, v22, v58
    v_add_f32 v20, v20, v54
    v_add_f32 v21, v21, v55
    v_add_f32 v22, v22, v59
    global_store_dwordx4 v1, v[20:23], s[16:17] sc1
    s_waitcnt vmcnt(0)
    s_mov_b64 exec, 1
    global_atomic_add v7, v131, v3, s[14:15] sc0
    s_waitcnt vmcnt(0)
    v_readfirstlane_b32 s44, v7
    s_mov_b64 exec, -1
    s_nop 2
    s_lshr_b32 s44, s44, s43
    s_and_b32 s44, s44, 0xff
    s_cmp_lg_u32 s44, 1
    s_cbranch_scc1 L_end
    global_load_dwordx4 v[48:51], v5, s[16:17] sc1
    s_waitcnt vmcnt(0)
    v_add_f32 v20, v20, v48
    v_add_f32 v21, v21, v49
    v_add_f32 v22, v22, v50
    v_add_f32 v22, 0x358637bd, v22
    v_div_scale_f32 v48, s[46:47], v22, v22, v20
    v_div_scale_f32 v49, vcc, v20, v22, v20
    v_rcp_f32 v50, v48
    s_nop 0
    v_fma_f32 v51, -v48, v50, 1.0
    v_fma_f32 v50, v51, v50, v50
    v_mul_f32 v51, v49, v50
    v_fma_f32 v52, -v48, v51, v49
    v_fma_f32 v51, v52, v50, v51
    v_fma_f32 v52, -v48, v51, v49
    v_div_fmas_f32 v51, v52, v50, v51
    v_div_fixup_f32 v20, v51, v22, v20
    v_div_scale_f32 v48, s[46:47], v22, v22, v21
    v_div_scale_f32 v49, vcc, v21, v22, v21
    v_rcp_f32 v50, v48
    s_nop 0
    v_fma_f32 v51, -v48, v50, 1.0
    v_fma_f32 v50, v51, v50, v50
    v_mul_f32 v51, v49, v50
    v_fma_f32 v52, -v48, v51, v49
    v_fma_f32 v51, v52, v50, v51
    v_fma_f32 v52, -v48, v51, v49
    v_div_fmas_f32 v51, v52, v50, v51
    v_div_fixup_f32 v21, v51, v22, v21
    v_cvt_pk_bf16_f32 v20, v20, v21
    global_store_dword v130, v20, s[12:13]
L_end:
    s_endpgm
.section .rodata,"a"
.p2align 6
.amdhsa_kernel standalone__linear_kernel_rfa__decode_kernel
  .amdhsa_next_free_vgpr 264
  .amdhsa_next_free_sgpr 72
  .amdhsa_accum_offset 172
  .amdhsa_group_segment_fixed_size 0
  .amdhsa_kernarg_size 56
  .amdhsa_user_sgpr_count 2
  .amdhsa_user_sgpr_kernarg_segment_ptr 1
  .amdhsa_system_sgpr_workgroup_id_x 1
  .amdhsa_float_denorm_mode_32 3
.end_amdhsa_kernel
```
